```python
import torch

def _softmax(x, axis=-1):
    return torch.softmax(x, dim=axis)
def _gelu(x):
    return torch.nn.functional.gelu(x, approximate="tanh")
def _silu(x):
    return torch.nn.functional.silu(x)
def _sigmoid(x):
    return torch.sigmoid(x)
def _layernorm(x, axis=-1, eps=1e-5):
    m = x.mean(dim=axis, keepdim=True)
    v = x.var(dim=axis, keepdim=True, unbiased=False)
    return (x - m) / torch.sqrt(v + eps)
def _scatter_add(tgt, idx, src, axis=0):
    return tgt.clone().index_add_(axis, idx, src)
def _segment_sum(src, seg, n):
    out = torch.zeros((n,) + src.shape[1:], dtype=src.dtype)
    return out.index_add_(0, seg, src)
def _pad(x, pw):
    flat = tuple(v for pair in reversed(pw) for v in pair)
    return torch.nn.functional.pad(x, flat)

kernel_name = 'parallel_sum__grouped_kv_mqa__dense_activation_gelu__prompt'

def setup_inputs():

    _w = (lambda a: (lambda t: t.to(torch.bfloat16) if t.is_floating_point() else t)(torch.as_tensor(a)))
    def _A_setup():
        B, S, D, H = 1, 2048, 640, 32
        Dh = D // H
        return {
            "x": _w((lambda *s: torch.randn(*s, dtype=torch.bfloat16) * 0.05)(B, S, D)),
            "wq": _w((lambda *s: torch.randn(*s, dtype=torch.bfloat16) * 0.1)(D, H * Dh)),
            "wk": _w((lambda *s: torch.randn(*s, dtype=torch.bfloat16) * 0.1)(D, Dh)),
            "wv": _w((lambda *s: torch.randn(*s, dtype=torch.bfloat16) * 0.05)(D, Dh)),
            "wo": _w((lambda *s: torch.randn(*s, dtype=torch.bfloat16) * 0.05)(H * Dh, D)),
        }
    _A_in = _A_setup()

    def _B_setup():
        B, S, D, F = 1, 2048, 640, 1728
        return {
            "x": _w((lambda *s: torch.randn(*s, dtype=torch.bfloat16) * 0.05)(B, S, D)),
            "w1": _w((lambda *s: torch.randn(*s, dtype=torch.bfloat16) * 1.6)(D, F) * (D ** -0.5)),
            "b1": _w((lambda *s: torch.randn(*s, dtype=torch.bfloat16) * 1.6)(F) * 0.01),
            "w2": _w((lambda *s: torch.randn(*s, dtype=torch.bfloat16) * 1.6)(F, D) * (F ** -0.5)),
            "b2": _w((lambda *s: torch.randn(*s, dtype=torch.bfloat16) * 0.8)(D) * 0.01),
        }
    _B_in = _B_setup()

    return {
        "A_x": _A_in["x"],
        "A_wq": _A_in["wq"],
        "A_wk": _A_in["wk"],
        "A_wv": _A_in["wv"],
        "A_wo": _A_in["wo"],
        "B_x": _B_in["x"],
        "B_w1": _B_in["w1"],
        "B_b1": _B_in["b1"],
        "B_w2": _B_in["w2"],
        "B_b2": _B_in["b2"],
    }

def reference(A_x, A_wq, A_wk, A_wv, A_wo, B_x, B_w1, B_b1, B_w2, B_b2):
    def _A_ref(x, wq, wk, wv, wo):
        B, S, D = x.shape
        H = 32
        Dh = D // H
        q = (lambda x, *d: x.permute(*d))((x @ wq).reshape(B, S, H, Dh), 0, 2, 1, 3)
        k = x @ wk
        v = x @ wv
        scores = torch.einsum("bhqd,bkd->bhqk", q, k) * (Dh ** -0.5)
        p = _softmax(scores, axis=-1)
        o = torch.einsum("bhqk,bkd->bhqd", p, v)
        return (lambda x, *d: x.permute(*d))(o, 0, 2, 1, 3).reshape(B, S, H * Dh) @ wo

    def _B_ref(x, w1, b1, w2, b2):
        h = torch.einsum("bsd,df->bsf", x, w1) + b1
        h = _gelu(h)
        return torch.einsum("bsf,fd->bsd", h, w2) + b2

    x = A_x
    xn = _layernorm(x, axis=-1)
    return x + _A_ref(xn, A_wq, A_wk, A_wv, A_wo) + _B_ref(xn, B_w1, B_b1, B_w2, B_b2)
```

```asm
; @launch kernel=k1_kernel grid=(256,1,1) block=(768,1,1) lds=155136
; @launch kernel=k2_kernel grid=(256,1,1) block=(768,1,1) lds=163840
.amdgcn_target "amdgcn-amd-amdhsa--gfx950"
.text
.globl k1_kernel
.p2align 8
.type k1_kernel,@function
k1_kernel:
    s_cmp_ge_u32 s2, 256
    s_cbranch_scc1 K1_END
    s_getpc_b64 s[4:5]
K1_PC:
    v_lshlrev_b32 v1, 7, v0
    s_sub_u32 s4, s4, K1_PC-k1_kernel
    s_subb_u32 s5, s5, 0
    s_and_b32 s5, s5, 0xffff
    s_mov_b32 s6, CODE_END-k1_kernel
    s_mov_b32 s7, 0x20000
    buffer_load_dword v167, v1, s[4:7], 0 offen
    s_load_dwordx4 s[24:27], s[0:1], 0
    s_load_dwordx4 s[36:39], s[0:1], 48
    s_load_dwordx4 s[28:31], s[0:1], 16
    s_load_dwordx2 s[32:33], s[0:1], 32
    s_load_dwordx2 s[40:41], s[0:1], 64
    s_load_dwordx4 s[76:79], s[0:1], 88
    v_lshrrev_b32 v1, 6, v0
    v_and_b32 v0, 63, v0
    v_readfirstlane_b32 s52, v1
    s_and_b32 s3, s2, 7
    s_lshr_b32 s64, s2, 3
    s_and_b32 s55, s3, 1
    s_lshl_b32 s55, s55, 3
    s_and_b32 s65, s64, 7
    s_add_u32 s55, s55, s65
    s_lshr_b32 s56, s3, 1
    s_lshl_b32 s56, s56, 2
    s_lshr_b32 s65, s64, 3
    s_add_u32 s56, s56, s65
    s_sub_u32 s56, s56, 1
    s_min_u32 s56, s56, 15
    s_and_b32 s53, s52, 3
    s_lshr_b32 s54, s52, 2
    s_cmp_lt_u32 s56, 4
    s_cselect_b32 s63, 0, 1
    s_cselect_b32 s75, 0, 4
    s_movk_i32 s57, 3456
    s_cselect_b32 s57, 1280, s57
    s_sub_u32 s75, s56, s75
    s_mul_i32 s74, s75, 10
    s_mul_i32 s75, s75, 320
    s_cmp_eq_u32 s56, 15
    s_cbranch_scc1 K1_KV
    s_cmp_lg_u32 s54, 2
    s_cbranch_scc1 K1_NOTL
    s_setprio 3
    s_lshl_b32 s61, s53, 12
    s_mul_i32 s60, s53, 5120
    s_lshr_b32 s69, s2, 3
    s_mul_i32 s64, s69, 26
    s_lshr_b32 s64, s64, 8
    s_mul_i32 s64, s64, 10
    s_sub_u32 s69, s69, s64
    s_lshl_b32 s64, s55, 7
    s_lshl_b32 s65, s53, 5
    s_add_u32 s64, s64, s65
    v_lshrrev_b32 v1, 3, v0
    v_add_u32 v1, s64, v1
    v_mul_u32_u24 v3, 1280, v1
    v_and_b32 v1, 7, v0
    v_lshrrev_b32 v4, 4, v0
    v_xor_b32 v1, v1, v4
    v_lshlrev_b32 v1, 4, v1
    v_xor_b32 v4, 64, v1
    v_add_u32 v4, v3, v4
    v_add_u32 v4, 10240, v4
    v_add_u32 v3, v3, v1
    v_lshlrev_b32 v5, 4, v0
    s_lshl_b32 s64, s53, 4
    s_mul_i32 s64, s64, s57
    v_add_u32 v1, 0, v0
    v_mul_u32_u24 v2, 3277, v1
    v_lshrrev_b32 v2, 16, v2
    v_mul_u32_u24 v6, 20, v2
    v_sub_u32 v1, v1, v6
    v_mul_u32_u24 v6, s57, v2
    v_lshl_add_u32 v6, v1, 4, v6
    v_add_u32 v6, s64, v6
    v_add_u32 v1, 64, v0
    v_mul_u32_u24 v2, 3277, v1
    v_lshrrev_b32 v2, 16, v2
    v_mul_u32_u24 v7, 20, v2
    v_sub_u32 v1, v1, v7
    v_mul_u32_u24 v7, s57, v2
    v_lshl_add_u32 v7, v1, 4, v7
    v_add_u32 v7, s64, v7
    v_add_u32 v1, 128, v0
    v_mul_u32_u24 v2, 3277, v1
    v_lshrrev_b32 v2, 16, v2
    v_mul_u32_u24 v8, 20, v2
    v_sub_u32 v1, v1, v8
    v_mul_u32_u24 v8, s57, v2
    v_lshl_add_u32 v8, v1, 4, v8
    v_add_u32 v8, s64, v8
    v_add_u32 v1, 192, v0
    v_mul_u32_u24 v2, 3277, v1
    v_lshrrev_b32 v2, 16, v2
    v_mul_u32_u24 v9, 20, v2
    v_sub_u32 v1, v1, v9
    v_mul_u32_u24 v9, s57, v2
    v_lshl_add_u32 v9, v1, 4, v9
    v_add_u32 v9, s64, v9
    v_add_u32 v1, 256, v0
    v_mul_u32_u24 v2, 3277, v1
    v_lshrrev_b32 v2, 16, v2
    v_mul_u32_u24 v10, 20, v2
    v_sub_u32 v1, v1, v10
    v_mul_u32_u24 v10, s57, v2
    v_lshl_add_u32 v10, v1, 4, v10
    v_add_u32 v10, s64, v10
    s_mov_b32 s73, 0
    s_waitcnt lgkmcnt(0)
    s_mov_b32 s42, s78
    s_mov_b32 s43, s79
    s_mov_b32 s6, s76
    s_mov_b32 s7, s77
    s_mov_b32 s8, s24
    s_and_b32 s9, s25, 0xffff
    s_mov_b32 s10, 2621440
    s_mov_b32 s11, 0x20000
    s_cmp_eq_u32 s63, 0
    s_cselect_b32 s12, s26, s36
    s_cselect_b32 s13, s27, s37
    s_mov_b32 s14, 2211840
    s_cselect_b32 s14, 819200, s14
    s_add_u32 s12, s12, s75
    s_addc_u32 s13, s13, 0
    s_and_b32 s13, s13, 0xffff
    s_sub_u32 s14, s14, s75
    s_mov_b32 s15, 0x20000
    s_lshl_b32 s58, s69, 6
    s_mul_i32 s58, s57, s58
    s_add_u32 s71, s60, s73
    s_add_u32 m0, s71, 0
    s_nop 0
    buffer_load_dwordx4 v6, s[12:15], s58 offen lds
    s_add_u32 m0, s71, 1024
    s_nop 0
    buffer_load_dwordx4 v7, s[12:15], s58 offen lds
    s_add_u32 m0, s71, 2048
    s_nop 0
    buffer_load_dwordx4 v8, s[12:15], s58 offen lds
    s_add_u32 m0, s71, 3072
    s_nop 0
    buffer_load_dwordx4 v9, s[12:15], s58 offen lds
    s_add_u32 m0, s71, 4096
    s_nop 0
    buffer_load_dwordx4 v10, s[12:15], s58 offen lds
    s_lshl_b32 s70, s69, 7
    s_add_u32 s71, s61, s73
    s_add_u32 m0, s71, 20480
    s_add_u32 s59, s70, 0
    buffer_load_dwordx4 v3, s[8:11], s59 offen lds
    s_add_u32 m0, s71, 21504
    s_add_u32 s59, s70, 0
    buffer_load_dwordx4 v4, s[8:11], s59 offen lds
    s_add_u32 m0, s71, 22528
    s_add_u32 s59, s70, 20480
    buffer_load_dwordx4 v3, s[8:11], s59 offen lds
    s_add_u32 m0, s71, 23552
    s_add_u32 s59, s70, 20480
    buffer_load_dwordx4 v4, s[8:11], s59 offen lds
    s_add_u32 s69, s69, 1
    s_cmp_eq_u32 s69, 10
    s_cselect_b32 s69, 0, s69
    s_add_u32 s73, s73, 36864
    s_cmp_eq_u32 s73, 147456
    s_cselect_b32 s73, 0, s73
    s_lshl_b32 s58, s69, 6
    s_mul_i32 s58, s57, s58
    s_add_u32 s71, s60, s73
    s_add_u32 m0, s71, 0
    s_nop 0
    buffer_load_dwordx4 v6, s[12:15], s58 offen lds
    s_add_u32 m0, s71, 1024
    s_nop 0
    buffer_load_dwordx4 v7, s[12:15], s58 offen lds
    s_add_u32 m0, s71, 2048
    s_nop 0
    buffer_load_dwordx4 v8, s[12:15], s58 offen lds
    s_add_u32 m0, s71, 3072
    s_nop 0
    buffer_load_dwordx4 v9, s[12:15], s58 offen lds
    s_add_u32 m0, s71, 4096
    s_nop 0
    buffer_load_dwordx4 v10, s[12:15], s58 offen lds
    s_lshl_b32 s70, s69, 7
    s_add_u32 s71, s61, s73
    s_add_u32 m0, s71, 20480
    s_add_u32 s59, s70, 0
    buffer_load_dwordx4 v3, s[8:11], s59 offen lds
    s_add_u32 m0, s71, 21504
    s_add_u32 s59, s70, 0
    buffer_load_dwordx4 v4, s[8:11], s59 offen lds
    s_add_u32 m0, s71, 22528
    s_add_u32 s59, s70, 20480
    buffer_load_dwordx4 v3, s[8:11], s59 offen lds
    s_add_u32 m0, s71, 23552
    s_add_u32 s59, s70, 20480
    buffer_load_dwordx4 v4, s[8:11], s59 offen lds
    s_add_u32 s69, s69, 1
    s_cmp_eq_u32 s69, 10
    s_cselect_b32 s69, 0, s69
    s_add_u32 s73, s73, 36864
    s_cmp_eq_u32 s73, 147456
    s_cselect_b32 s73, 0, s73
    s_mov_b32 s16, s42
    s_and_b32 s17, s43, 0xffff
    s_mov_b32 s18, 21872640
    s_mov_b32 s19, 0x20000
    s_mov_b32 s72, 5120
    s_sub_u32 s5, s2, 108
    s_cmp_lt_u32 s5, 108
    s_cselect_b32 s64, s40, s32
    s_cselect_b32 s65, s41, s33
    s_cselect_b32 s68, s5, 0
    s_mov_b32 s66, 552960
    s_mov_b32 s67, 9863168
    s_mul_i32 s3, s68, 20480
    s_cbranch_scc1 K1_SJ1
    s_mov_b32 s66, 204800
    s_mov_b32 s67, 12075008
    s_sub_u32 s68, s5, 108
    s_mul_i32 s3, s68, 26
    s_lshr_b32 s3, s3, 8
    s_mul_i32 s4, s3, 10
    s_sub_u32 s4, s68, s4
    s_cmp_lt_u32 s4, 8
    s_cbranch_scc0 K1_SJR
    s_lshl_b32 s3, s3, 3
    s_add_u32 s3, s3, s4
    s_mul_i32 s3, s3, 25600
    s_branch K1_SJ1
K1_SJR:
    s_lshl_b32 s3, s3, 1
    s_add_u32 s3, s3, s4
    s_sub_u32 s3, s3, 8
    s_mul_i32 s3, s3, 102400
    s_add_u32 s3, s3, 20480
    s_mov_b32 s72, 25600
K1_SJ1:
    s_add_u32 s44, s64, s3
    s_addc_u32 s45, s65, 0
    s_and_b32 s45, s45, 0xffff
    s_mul_i32 s4, s72, 3
    s_add_u32 s4, s4, 5120
    s_cmp_lt_u32 s5, 148
    s_cselect_b32 s46, s4, 0
    s_cselect_b32 s50, 21872640, 0
    s_mov_b32 s47, 0x20000
    s_mov_b32 s48, s42
    s_and_b32 s49, s43, 0xffff
    s_mov_b32 s51, 0x20000
    s_mul_i32 s3, s68, 5120
    s_add_u32 s67, s67, s3
    v_lshrrev_b32 v11, 5, v0
    v_mul_u32_u24 v11, 4, v11
    v_bfe_u32 v1, v0, 2, 2
    v_add_u32 v11, v11, v1
    v_mul_u32_u24 v11, 1280, v11
    v_bfe_u32 v1, v0, 4, 1
    v_lshl_add_u32 v11, v1, 5, v11
    v_and_b32 v1, 3, v0
    v_lshl_add_u32 v11, v1, 3, v11
    v_add_u32 v11, 73728, v11
    v_lshrrev_b32 v12, 5, v0
    v_mul_u32_u24 v12, 8, v12
    v_bfe_u32 v1, v0, 2, 2
    v_add_u32 v12, v12, v1
    v_mul_u32_u24 v12, 320, v12
    v_bfe_u32 v1, v0, 4, 1
    v_lshl_add_u32 v12, v1, 5, v12
    v_and_b32 v1, 3, v0
    v_lshl_add_u32 v12, v1, 3, v12
    s_mul_i32 s64, s53, 5120
    v_add_u32 v12, s64, v12
    v_mov_b32 v18, 0
    v_mov_b32 v19, 0
    v_mov_b32 v20, 0
    v_mov_b32 v21, 0
    s_mov_b32 s62, 0
    s_mov_b32 s63, 0xffff0000
    s_waitcnt vmcnt(9)
    s_barrier
    v_add_u32 v13, s62, v12
    ds_read_b64_tr_b16 v[24:25], v13 offset:192
    ds_read_b64_tr_b16 v[26:27], v13 offset:1472
    ds_read_b64_tr_b16 v[28:29], v13 offset:256
    ds_read_b64_tr_b16 v[30:31], v13 offset:1536
    s_add_u32 s62, s62, 36864
    s_cmp_eq_u32 s62, 147456
    s_cselect_b32 s62, 0, s62
    s_lshl_b32 s58, s69, 6
    s_mul_i32 s58, s57, s58
    s_add_u32 s71, s60, s73
    s_add_u32 m0, s71, 0
    s_nop 0
    buffer_load_dwordx4 v6, s[12:15], s58 offen lds
    s_add_u32 m0, s71, 1024
    s_nop 0
    buffer_load_dwordx4 v7, s[12:15], s58 offen lds
    s_waitcnt lgkmcnt(0)
    v_lshlrev_b32 v14, 16, v24
    v_and_b32 v15, s63, v24
    s_add_u32 m0, s71, 2048
    s_nop 0
    buffer_load_dwordx4 v8, s[12:15], s58 offen lds
    v_lshlrev_b32 v16, 16, v28
    v_and_b32 v17, s63, v28
    s_add_u32 m0, s71, 3072
    s_nop 0
    buffer_load_dwordx4 v9, s[12:15], s58 offen lds
    v_add_f32 v18, v18, v14
    v_add_f32 v20, v20, v15
    s_add_u32 m0, s71, 4096
    s_nop 0
    buffer_load_dwordx4 v10, s[12:15], s58 offen lds
    v_add_f32 v19, v19, v16
    v_add_f32 v21, v21, v17
    s_lshl_b32 s70, s69, 7
    s_add_u32 s71, s61, s73
    s_add_u32 m0, s71, 20480
    s_add_u32 s59, s70, 0
    buffer_load_dwordx4 v3, s[8:11], s59 offen lds
    v_lshlrev_b32 v14, 16, v25
    v_and_b32 v15, s63, v25
    s_add_u32 m0, s71, 21504
    s_add_u32 s59, s70, 0
    buffer_load_dwordx4 v4, s[8:11], s59 offen lds
    v_lshlrev_b32 v16, 16, v29
    v_and_b32 v17, s63, v29
    s_add_u32 m0, s71, 22528
    s_add_u32 s59, s70, 20480
    buffer_load_dwordx4 v3, s[8:11], s59 offen lds
    v_add_f32 v18, v18, v14
    v_add_f32 v20, v20, v15
    s_add_u32 m0, s71, 23552
    s_add_u32 s59, s70, 20480
    buffer_load_dwordx4 v4, s[8:11], s59 offen lds
    v_add_f32 v19, v19, v16
    v_add_f32 v21, v21, v17
    s_add_u32 s69, s69, 1
    s_cmp_eq_u32 s69, 10
    s_cselect_b32 s69, 0, s69
    s_add_u32 s73, s73, 36864
    s_cmp_eq_u32 s73, 147456
    s_cselect_b32 s73, 0, s73
    s_lshl_b32 s58, s69, 6
    s_mul_i32 s58, s57, s58
    s_add_u32 s71, s60, s73
    s_add_u32 m0, s71, 0
    s_nop 0
    buffer_load_dwordx4 v6, s[12:15], s58 offen lds
    v_lshlrev_b32 v14, 16, v26
    v_and_b32 v15, s63, v26
    s_add_u32 m0, s71, 1024
    s_nop 0
    buffer_load_dwordx4 v7, s[12:15], s58 offen lds
    v_lshlrev_b32 v16, 16, v30
    v_and_b32 v17, s63, v30
    s_add_u32 m0, s71, 2048
    s_nop 0
    buffer_load_dwordx4 v8, s[12:15], s58 offen lds
    v_add_f32 v18, v18, v14
    v_add_f32 v20, v20, v15
    s_add_u32 m0, s71, 3072
    s_nop 0
    buffer_load_dwordx4 v9, s[12:15], s58 offen lds
    v_add_f32 v19, v19, v16
    v_add_f32 v21, v21, v17
    s_add_u32 m0, s71, 4096
    s_nop 0
    buffer_load_dwordx4 v10, s[12:15], s58 offen lds
    v_lshlrev_b32 v14, 16, v27
    v_and_b32 v15, s63, v27
    s_lshl_b32 s70, s69, 7
    s_add_u32 s71, s61, s73
    s_add_u32 m0, s71, 20480
    s_add_u32 s59, s70, 0
    buffer_load_dwordx4 v3, s[8:11], s59 offen lds
    v_lshlrev_b32 v16, 16, v31
    v_and_b32 v17, s63, v31
    s_add_u32 m0, s71, 21504
    s_add_u32 s59, s70, 0
    buffer_load_dwordx4 v4, s[8:11], s59 offen lds
    v_add_f32 v18, v18, v14
    v_add_f32 v20, v20, v15
    s_add_u32 m0, s71, 22528
    s_add_u32 s59, s70, 20480
    buffer_load_dwordx4 v3, s[8:11], s59 offen lds
    v_add_f32 v19, v19, v16
    s_add_u32 m0, s71, 23552
    s_add_u32 s59, s70, 20480
    buffer_load_dwordx4 v4, s[8:11], s59 offen lds
    v_add_f32 v21, v21, v17
    s_add_u32 s69, s69, 1
    s_cmp_eq_u32 s69, 10
    s_cselect_b32 s69, 0, s69
    s_add_u32 s73, s73, 36864
    s_cmp_eq_u32 s73, 147456
    s_cselect_b32 s73, 0, s73
    s_setprio 1
    s_mov_b32 s74, 0
K1L_LOOP:
    s_waitcnt vmcnt(18)
    s_barrier
    v_add_u32 v13, s62, v12
    ds_read_b64_tr_b16 v[24:25], v13 offset:192
    ds_read_b64_tr_b16 v[26:27], v13 offset:1472
    ds_read_b64_tr_b16 v[28:29], v13 offset:256
    ds_read_b64_tr_b16 v[30:31], v13 offset:1536
    s_add_u32 s62, s62, 36864
    s_cmp_eq_u32 s62, 147456
    s_cselect_b32 s62, 0, s62
    s_lshl_b32 s58, s69, 6
    s_mul_i32 s58, s57, s58
    s_add_u32 s71, s60, s73
    s_add_u32 m0, s71, 0
    s_nop 0
    buffer_load_dwordx4 v6, s[12:15], s58 offen lds
    s_add_u32 m0, s71, 1024
    s_nop 0
    buffer_load_dwordx4 v7, s[12:15], s58 offen lds
    s_waitcnt lgkmcnt(0)
    v_lshlrev_b32 v14, 16, v24
    v_and_b32 v15, s63, v24
    v_lshlrev_b32 v16, 16, v28
    v_and_b32 v17, s63, v28
    s_add_u32 m0, s71, 2048
    s_nop 0
    buffer_load_dwordx4 v8, s[12:15], s58 offen lds
    v_add_f32 v18, v18, v14
    v_add_f32 v20, v20, v15
    v_add_f32 v19, v19, v16
    v_add_f32 v21, v21, v17
    s_add_u32 m0, s71, 3072
    s_nop 0
    buffer_load_dwordx4 v9, s[12:15], s58 offen lds
    v_lshlrev_b32 v14, 16, v25
    v_and_b32 v15, s63, v25
    v_lshlrev_b32 v16, 16, v29
    v_and_b32 v17, s63, v29
    s_add_u32 m0, s71, 4096
    s_nop 0
    buffer_load_dwordx4 v10, s[12:15], s58 offen lds
    v_add_f32 v18, v18, v14
    v_add_f32 v20, v20, v15
    v_add_f32 v19, v19, v16
    v_add_f32 v21, v21, v17
    s_lshl_b32 s70, s69, 7
    s_add_u32 s71, s61, s73
    s_add_u32 m0, s71, 20480
    s_add_u32 s59, s70, 0
    buffer_load_dwordx4 v3, s[8:11], s59 offen lds
    v_lshlrev_b32 v14, 16, v26
    v_and_b32 v15, s63, v26
    v_lshlrev_b32 v16, 16, v30
    v_and_b32 v17, s63, v30
    s_add_u32 m0, s71, 21504
    s_add_u32 s59, s70, 0
    buffer_load_dwordx4 v4, s[8:11], s59 offen lds
    v_add_f32 v18, v18, v14
    v_add_f32 v20, v20, v15
    v_add_f32 v19, v19, v16
    v_add_f32 v21, v21, v17
    s_add_u32 m0, s71, 22528
    s_add_u32 s59, s70, 20480
    buffer_load_dwordx4 v3, s[8:11], s59 offen lds
    v_lshlrev_b32 v14, 16, v27
    v_and_b32 v15, s63, v27
    v_lshlrev_b32 v16, 16, v31
    v_and_b32 v17, s63, v31
    s_add_u32 m0, s71, 23552
    s_add_u32 s59, s70, 20480
    buffer_load_dwordx4 v4, s[8:11], s59 offen lds
    v_add_f32 v18, v18, v14
    v_add_f32 v20, v20, v15
    v_add_f32 v19, v19, v16
    v_add_f32 v21, v21, v17
    s_add_u32 s69, s69, 1
    s_cmp_eq_u32 s69, 10
    s_cselect_b32 s69, 0, s69
    s_add_u32 s73, s73, 36864
    s_cmp_eq_u32 s73, 147456
    s_cselect_b32 s73, 0, s73
    s_add_u32 s74, s74, 1
    s_cmp_lt_u32 s74, 6
    s_cbranch_scc1 K1L_LOOP
    s_waitcnt vmcnt(18)
    s_barrier
    v_add_u32 v13, s62, v12
    ds_read_b64_tr_b16 v[24:25], v13 offset:192
    ds_read_b64_tr_b16 v[26:27], v13 offset:1472
    ds_read_b64_tr_b16 v[28:29], v13 offset:256
    ds_read_b64_tr_b16 v[30:31], v13 offset:1536
    s_add_u32 s62, s62, 36864
    s_cmp_eq_u32 s62, 147456
    s_cselect_b32 s62, 0, s62
    s_add_u32 m0, s60, 73728
    s_mul_i32 s64, s72, s53
    s_add_u32 s64, s64, 0
    buffer_load_dwordx4 v5, s[44:47], s64 offen lds
    s_add_u32 m0, s60, 74752
    s_mul_i32 s64, s72, s53
    s_add_u32 s64, s64, 1024
    buffer_load_dwordx4 v5, s[44:47], s64 offen lds
    s_waitcnt lgkmcnt(0)
    v_lshlrev_b32 v14, 16, v24
    v_and_b32 v15, s63, v24
    v_lshlrev_b32 v16, 16, v28
    v_and_b32 v17, s63, v28
    v_add_f32 v18, v18, v14
    v_add_f32 v20, v20, v15
    v_add_f32 v19, v19, v16
    v_add_f32 v21, v21, v17
    s_add_u32 m0, s60, 75776
    s_mul_i32 s64, s72, s53
    s_add_u32 s64, s64, 2048
    buffer_load_dwordx4 v5, s[44:47], s64 offen lds
    v_lshlrev_b32 v14, 16, v25
    v_and_b32 v15, s63, v25
    v_lshlrev_b32 v16, 16, v29
    v_and_b32 v17, s63, v29
    v_add_f32 v18, v18, v14
    v_add_f32 v20, v20, v15
    v_add_f32 v19, v19, v16
    v_add_f32 v21, v21, v17
    s_add_u32 m0, s60, 76800
    s_mul_i32 s64, s72, s53
    s_add_u32 s64, s64, 3072
    buffer_load_dwordx4 v5, s[44:47], s64 offen lds
    v_lshlrev_b32 v14, 16, v26
    v_and_b32 v15, s63, v26
    v_lshlrev_b32 v16, 16, v30
    v_and_b32 v17, s63, v30
    v_add_f32 v18, v18, v14
    v_add_f32 v20, v20, v15
    v_add_f32 v19, v19, v16
    v_add_f32 v21, v21, v17
    s_add_u32 m0, s60, 77824
    s_mul_i32 s64, s72, s53
    s_add_u32 s64, s64, 4096
    buffer_load_dwordx4 v5, s[44:47], s64 offen lds
    v_lshlrev_b32 v14, 16, v27
    v_and_b32 v15, s63, v27
    v_lshlrev_b32 v16, 16, v31
    v_and_b32 v17, s63, v31
    v_add_f32 v18, v18, v14
    v_add_f32 v20, v20, v15
    v_add_f32 v19, v19, v16
    v_add_f32 v21, v21, v17
    s_waitcnt vmcnt(14)
    s_barrier
    v_add_u32 v13, s62, v12
    ds_read_b64_tr_b16 v[24:25], v13 offset:192
    ds_read_b64_tr_b16 v[26:27], v13 offset:1472
    ds_read_b64_tr_b16 v[28:29], v13 offset:256
    ds_read_b64_tr_b16 v[30:31], v13 offset:1536
    s_add_u32 s62, s62, 36864
    s_cmp_eq_u32 s62, 147456
    s_cselect_b32 s62, 0, s62
    s_waitcnt lgkmcnt(0)
    v_lshlrev_b32 v14, 16, v24
    v_and_b32 v15, s63, v24
    v_lshlrev_b32 v16, 16, v28
    v_and_b32 v17, s63, v28
    v_add_f32 v18, v18, v14
    v_add_f32 v20, v20, v15
    v_add_f32 v19, v19, v16
    v_add_f32 v21, v21, v17
    v_lshlrev_b32 v14, 16, v25
    v_and_b32 v15, s63, v25
    v_lshlrev_b32 v16, 16, v29
    v_and_b32 v17, s63, v29
    v_add_f32 v18, v18, v14
    v_add_f32 v20, v20, v15
    v_add_f32 v19, v19, v16
    v_add_f32 v21, v21, v17
    v_lshlrev_b32 v14, 16, v26
    v_and_b32 v15, s63, v26
    v_lshlrev_b32 v16, 16, v30
    v_and_b32 v17, s63, v30
    v_add_f32 v18, v18, v14
    v_add_f32 v20, v20, v15
    v_add_f32 v19, v19, v16
    v_add_f32 v21, v21, v17
    v_lshlrev_b32 v14, 16, v27
    v_and_b32 v15, s63, v27
    v_lshlrev_b32 v16, 16, v31
    v_and_b32 v17, s63, v31
    v_add_f32 v18, v18, v14
    v_add_f32 v20, v20, v15
    v_add_f32 v19, v19, v16
    v_add_f32 v21, v21, v17
    s_waitcnt vmcnt(0)
    s_barrier
    v_add_u32 v13, s62, v12
    ds_read_b64_tr_b16 v[24:25], v13 offset:192
    ds_read_b64_tr_b16 v[26:27], v13 offset:1472
    ds_read_b64_tr_b16 v[28:29], v13 offset:256
    ds_read_b64_tr_b16 v[30:31], v13 offset:1536
    s_add_u32 s62, s62, 36864
    s_cmp_eq_u32 s62, 147456
    s_cselect_b32 s62, 0, s62
    s_waitcnt lgkmcnt(0)
    v_lshlrev_b32 v14, 16, v24
    v_and_b32 v15, s63, v24
    v_lshlrev_b32 v16, 16, v28
    v_and_b32 v17, s63, v28
    v_add_f32 v18, v18, v14
    v_add_f32 v20, v20, v15
    v_add_f32 v19, v19, v16
    v_add_f32 v21, v21, v17
    v_lshlrev_b32 v14, 16, v25
    v_and_b32 v15, s63, v25
    v_lshlrev_b32 v16, 16, v29
    v_and_b32 v17, s63, v29
    v_add_f32 v18, v18, v14
    v_add_f32 v20, v20, v15
    v_add_f32 v19, v19, v16
    v_add_f32 v21, v21, v17
    v_lshlrev_b32 v14, 16, v26
    v_and_b32 v15, s63, v26
    v_lshlrev_b32 v16, 16, v30
    v_and_b32 v17, s63, v30
    v_add_f32 v18, v18, v14
    v_add_f32 v20, v20, v15
    v_add_f32 v19, v19, v16
    v_add_f32 v21, v21, v17
    v_lshlrev_b32 v14, 16, v27
    v_and_b32 v15, s63, v27
    v_lshlrev_b32 v16, 16, v31
    v_and_b32 v17, s63, v31
    v_add_f32 v18, v18, v14
    v_add_f32 v20, v20, v15
    v_add_f32 v19, v19, v16
    v_add_f32 v21, v21, v17
    v_add_f32 v18, v18, v20
    v_add_f32 v19, v19, v21
    v_and_b32 v1, 31, v0
    v_lshlrev_b32 v1, 5, v1
    v_lshrrev_b32 v2, 5, v0
    v_lshl_add_u32 v1, v2, 2, v1
    s_lshl_b32 s64, s53, 3
    v_add_u32 v1, s64, v1
    v_add_u32 v1, 147456, v1
    ds_write_b32 v1, v18 offset:3072
    ds_write_b32 v1, v19 offset:4096
    s_mul_i32 s64, s53, 320
    v_add_u32 v1, s64, v11
    ds_read_b64_tr_b16 v[32:33], v1 offset:0
    ds_read_b64_tr_b16 v[34:35], v1 offset:10240
    ds_read_b64_tr_b16 v[36:37], v1 offset:64
    ds_read_b64_tr_b16 v[38:39], v1 offset:10304
    ds_read_b64_tr_b16 v[40:41], v1 offset:128
    ds_read_b64_tr_b16 v[42:43], v1 offset:10368
    ds_read_b64_tr_b16 v[44:45], v1 offset:192
    ds_read_b64_tr_b16 v[46:47], v1 offset:10432
    ds_read_b64_tr_b16 v[48:49], v1 offset:256
    ds_read_b64_tr_b16 v[50:51], v1 offset:10496
    s_waitcnt lgkmcnt(0)
    s_barrier
    s_mul_i32 s65, s53, s66
    s_add_u32 s65, s65, s67
    s_add_u32 s64, s65, 0
    buffer_store_dwordx4 v[32:35], v5, s[48:51], s64 offen sc0 sc1
    s_add_u32 s64, s65, 1024
    buffer_store_dwordx4 v[36:39], v5, s[48:51], s64 offen sc0 sc1
    s_add_u32 s64, s65, 2048
    buffer_store_dwordx4 v[40:43], v5, s[48:51], s64 offen sc0 sc1
    s_add_u32 s64, s65, 3072
    buffer_store_dwordx4 v[44:47], v5, s[48:51], s64 offen sc0 sc1
    s_add_u32 s64, s65, 4096
    buffer_store_dwordx4 v[48:51], v5, s[48:51], s64 offen sc0 sc1
    s_barrier
    s_endpgm
K1_NOTL:
    s_cmp_eq_u32 s54, 0
    s_cbranch_scc0 K1_MAIN1
    s_setprio 2
    s_waitcnt lgkmcnt(0)
    s_mov_b32 s42, s78
    s_mov_b32 s43, s79
    s_mov_b32 s6, s76
    s_mov_b32 s7, s77
    s_mov_b32 s16, s42
    s_and_b32 s17, s43, 0xffff
    s_mov_b32 s18, 21872640
    s_mov_b32 s19, 0x20000
    s_cmp_eq_u32 s63, 0
    s_cselect_b32 s64, 40, 108
    s_mov_b32 s65, 2621440
    s_cselect_b32 s65, 0, s65
    s_lshl_b32 s3, s55, 2
    s_add_u32 s3, s3, s53
    s_mul_i32 s3, s3, s64
    s_add_u32 s62, s74, s3
    s_lshl_b32 s62, s62, 10
    s_add_u32 s62, s62, s65
    v_lshlrev_b32 v13, 4, v0
    v_lshrrev_b32 v3, 5, v0
    v_mul_u32_u24 v3, 8, v3
    v_bfe_u32 v1, v0, 2, 2
    v_add_u32 v3, v3, v1
    v_mul_u32_u24 v3, 320, v3
    v_bfe_u32 v1, v0, 4, 1
    v_lshl_add_u32 v3, v1, 5, v3
    v_and_b32 v1, 3, v0
    v_lshl_add_u32 v3, v1, 3, v3
    v_and_b32 v1, 31, v0
    v_bfe_u32 v2, v0, 1, 3
    v_lshrrev_b32 v5, 5, v0
    v_xor_b32 v2, v2, v5
    v_lshlrev_b32 v2, 4, v2
    s_lshl_b32 s64, s53, 5
    v_add_u32 v1, s64, v1
    v_lshlrev_b32 v1, 7, v1
    v_add_u32 v1, v1, v2
    v_add_u32 v5, 20480, v1
    v_xor_b32 v6, 32, v5
    v_xor_b32 v7, 64, v5
    v_xor_b32 v8, 96, v5
    v_add_u32 v9, 73728, v5
    v_add_u32 v10, 73728, v6
    v_add_u32 v11, 73728, v7
    v_add_u32 v12, 73728, v8
    v_mov_b32 v4, v3
    v_mov_b32 v9, v5
    v_mov_b32 v10, v6
    v_mov_b32 v11, v7
    v_mov_b32 v12, v8
    v_mov_b32 v16, 0
    v_mov_b32 v17, 0
    v_mov_b32 v18, 0
    v_mov_b32 v19, 0
    v_mov_b32 v20, 0
    v_mov_b32 v21, 0
    v_mov_b32 v22, 0
    v_mov_b32 v23, 0
    v_mov_b32 v24, 0
    v_mov_b32 v25, 0
    v_mov_b32 v26, 0
    v_mov_b32 v27, 0
    v_mov_b32 v28, 0
    v_mov_b32 v29, 0
    v_mov_b32 v30, 0
    v_mov_b32 v31, 0
    v_mov_b32 v32, 0
    v_mov_b32 v33, 0
    v_mov_b32 v34, 0
    v_mov_b32 v35, 0
    v_mov_b32 v36, 0
    v_mov_b32 v37, 0
    v_mov_b32 v38, 0
    v_mov_b32 v39, 0
    v_mov_b32 v40, 0
    v_mov_b32 v41, 0
    v_mov_b32 v42, 0
    v_mov_b32 v43, 0
    v_mov_b32 v44, 0
    v_mov_b32 v45, 0
    v_mov_b32 v46, 0
    v_mov_b32 v47, 0
    v_mov_b32 v48, 0
    v_mov_b32 v49, 0
    v_mov_b32 v50, 0
    v_mov_b32 v51, 0
    v_mov_b32 v52, 0
    v_mov_b32 v53, 0
    v_mov_b32 v54, 0
    v_mov_b32 v55, 0
    v_mov_b32 v56, 0
    v_mov_b32 v57, 0
    v_mov_b32 v58, 0
    v_mov_b32 v59, 0
    v_mov_b32 v60, 0
    v_mov_b32 v61, 0
    v_mov_b32 v62, 0
    v_mov_b32 v63, 0
    v_mov_b32 v64, 0
    v_mov_b32 v65, 0
    v_mov_b32 v66, 0
    v_mov_b32 v67, 0
    v_mov_b32 v68, 0
    v_mov_b32 v69, 0
    v_mov_b32 v70, 0
    v_mov_b32 v71, 0
    v_mov_b32 v72, 0
    v_mov_b32 v73, 0
    v_mov_b32 v74, 0
    v_mov_b32 v75, 0
    v_mov_b32 v76, 0
    v_mov_b32 v77, 0
    v_mov_b32 v78, 0
    v_mov_b32 v79, 0
    v_mov_b32 v80, 0
    v_mov_b32 v81, 0
    v_mov_b32 v82, 0
    v_mov_b32 v83, 0
    v_mov_b32 v84, 0
    v_mov_b32 v85, 0
    v_mov_b32 v86, 0
    v_mov_b32 v87, 0
    v_mov_b32 v88, 0
    v_mov_b32 v89, 0
    v_mov_b32 v90, 0
    v_mov_b32 v91, 0
    v_mov_b32 v92, 0
    v_mov_b32 v93, 0
    v_mov_b32 v94, 0
    v_mov_b32 v95, 0
    s_mov_b32 s58, 36864
    s_mov_b32 s69, 0
    s_barrier
    ds_read_b128 v[136:139], v9
    ds_read_b64_tr_b16 v[96:97], v4 offset:0
    ds_read_b64_tr_b16 v[98:99], v4 offset:1280
    ds_read_b64_tr_b16 v[100:101], v4 offset:64
    ds_read_b64_tr_b16 v[102:103], v4 offset:1344
    ds_read_b64_tr_b16 v[104:105], v4 offset:128
    ds_read_b64_tr_b16 v[106:107], v4 offset:1408
    ds_read_b64_tr_b16 v[108:109], v4 offset:192
    ds_read_b64_tr_b16 v[110:111], v4 offset:1472
    ds_read_b64_tr_b16 v[112:113], v4 offset:256
    ds_read_b64_tr_b16 v[114:115], v4 offset:1536
K1C_LOOP:
    s_waitcnt lgkmcnt(0)
    v_mfma_f32_32x32x16_bf16 v[16:31], v[96:99], v[136:139], v[16:31]
    ds_read_b128 v[140:143], v10
    ds_read_b64_tr_b16 v[116:117], v4 offset:5120
    ds_read_b64_tr_b16 v[118:119], v4 offset:6400
    ds_read_b64_tr_b16 v[120:121], v4 offset:5184
    v_mfma_f32_32x32x16_bf16 v[32:47], v[100:103], v[136:139], v[32:47]
    ds_read_b64_tr_b16 v[122:123], v4 offset:6464
    ds_read_b64_tr_b16 v[124:125], v4 offset:5248
    ds_read_b64_tr_b16 v[126:127], v4 offset:6528
    ds_read_b64_tr_b16 v[128:129], v4 offset:5312
    v_mfma_f32_32x32x16_bf16 v[48:63], v[104:107], v[136:139], v[48:63]
    ds_read_b64_tr_b16 v[130:131], v4 offset:6592
    ds_read_b64_tr_b16 v[132:133], v4 offset:5376
    ds_read_b64_tr_b16 v[134:135], v4 offset:6656
    v_mfma_f32_32x32x16_bf16 v[64:79], v[108:111], v[136:139], v[64:79]
    v_add_u32 v144, s58, v3
    v_add_u32 v145, s58, v5
    v_mfma_f32_32x32x16_bf16 v[80:95], v[112:115], v[136:139], v[80:95]
    s_waitcnt lgkmcnt(0)
    v_mfma_f32_32x32x16_bf16 v[16:31], v[116:119], v[140:143], v[16:31]
    ds_read_b128 v[136:139], v11
    ds_read_b64_tr_b16 v[96:97], v4 offset:10240
    ds_read_b64_tr_b16 v[98:99], v4 offset:11520
    ds_read_b64_tr_b16 v[100:101], v4 offset:10304
    v_mfma_f32_32x32x16_bf16 v[32:47], v[120:123], v[140:143], v[32:47]
    ds_read_b64_tr_b16 v[102:103], v4 offset:11584
    ds_read_b64_tr_b16 v[104:105], v4 offset:10368
    ds_read_b64_tr_b16 v[106:107], v4 offset:11648
    ds_read_b64_tr_b16 v[108:109], v4 offset:10432
    v_mfma_f32_32x32x16_bf16 v[48:63], v[124:127], v[140:143], v[48:63]
    ds_read_b64_tr_b16 v[110:111], v4 offset:11712
    ds_read_b64_tr_b16 v[112:113], v4 offset:10496
    ds_read_b64_tr_b16 v[114:115], v4 offset:11776
    v_mfma_f32_32x32x16_bf16 v[64:79], v[128:131], v[140:143], v[64:79]
    v_mfma_f32_32x32x16_bf16 v[80:95], v[132:135], v[140:143], v[80:95]
    s_waitcnt lgkmcnt(0)
    v_mfma_f32_32x32x16_bf16 v[16:31], v[96:99], v[136:139], v[16:31]
    ds_read_b128 v[140:143], v12
    ds_read_b64_tr_b16 v[116:117], v4 offset:15360
    ds_read_b64_tr_b16 v[118:119], v4 offset:16640
    ds_read_b64_tr_b16 v[120:121], v4 offset:15424
    v_mfma_f32_32x32x16_bf16 v[32:47], v[100:103], v[136:139], v[32:47]
    ds_read_b64_tr_b16 v[122:123], v4 offset:16704
    ds_read_b64_tr_b16 v[124:125], v4 offset:15488
    ds_read_b64_tr_b16 v[126:127], v4 offset:16768
    ds_read_b64_tr_b16 v[128:129], v4 offset:15552
    v_mfma_f32_32x32x16_bf16 v[48:63], v[104:107], v[136:139], v[48:63]
    ds_read_b64_tr_b16 v[130:131], v4 offset:16832
    ds_read_b64_tr_b16 v[132:133], v4 offset:15616
    ds_read_b64_tr_b16 v[134:135], v4 offset:16896
    v_mfma_f32_32x32x16_bf16 v[64:79], v[108:111], v[136:139], v[64:79]
    v_mfma_f32_32x32x16_bf16 v[80:95], v[112:115], v[136:139], v[80:95]
    s_waitcnt lgkmcnt(0)
    s_barrier
    v_mfma_f32_32x32x16_bf16 v[16:31], v[116:119], v[140:143], v[16:31]
    ds_read_b128 v[136:139], v145
    ds_read_b64_tr_b16 v[96:97], v144 offset:0
    ds_read_b64_tr_b16 v[98:99], v144 offset:1280
    ds_read_b64_tr_b16 v[100:101], v144 offset:64
    v_mfma_f32_32x32x16_bf16 v[32:47], v[120:123], v[140:143], v[32:47]
    ds_read_b64_tr_b16 v[102:103], v144 offset:1344
    ds_read_b64_tr_b16 v[104:105], v144 offset:128
    ds_read_b64_tr_b16 v[106:107], v144 offset:1408
    ds_read_b64_tr_b16 v[108:109], v144 offset:192
    v_mfma_f32_32x32x16_bf16 v[48:63], v[124:127], v[140:143], v[48:63]
    ds_read_b64_tr_b16 v[110:111], v144 offset:1472
    ds_read_b64_tr_b16 v[112:113], v144 offset:256
    ds_read_b64_tr_b16 v[114:115], v144 offset:1536
    v_mfma_f32_32x32x16_bf16 v[64:79], v[128:131], v[140:143], v[64:79]
    v_add_u32 v4, s58, v3
    v_add_u32 v9, s58, v5
    v_add_u32 v10, s58, v6
    v_add_u32 v11, s58, v7
    v_add_u32 v12, s58, v8
    v_mfma_f32_32x32x16_bf16 v[80:95], v[132:135], v[140:143], v[80:95]
    s_add_u32 s58, s58, 36864
    s_cmp_eq_u32 s58, 147456
    s_cselect_b32 s58, 0, s58
    s_add_u32 s69, s69, 1
    s_cmp_lt_u32 s69, 9
    s_cbranch_scc1 K1C_LOOP
    s_waitcnt lgkmcnt(0)
    v_mfma_f32_32x32x16_bf16 v[16:31], v[96:99], v[136:139], v[16:31]
    ds_read_b128 v[140:143], v10
    ds_read_b64_tr_b16 v[116:117], v4 offset:5120
    ds_read_b64_tr_b16 v[118:119], v4 offset:6400
    ds_read_b64_tr_b16 v[120:121], v4 offset:5184
    v_mfma_f32_32x32x16_bf16 v[32:47], v[100:103], v[136:139], v[32:47]
    ds_read_b64_tr_b16 v[122:123], v4 offset:6464
    ds_read_b64_tr_b16 v[124:125], v4 offset:5248
    ds_read_b64_tr_b16 v[126:127], v4 offset:6528
    ds_read_b64_tr_b16 v[128:129], v4 offset:5312
    v_mfma_f32_32x32x16_bf16 v[48:63], v[104:107], v[136:139], v[48:63]
    ds_read_b64_tr_b16 v[130:131], v4 offset:6592
    ds_read_b64_tr_b16 v[132:133], v4 offset:5376
    ds_read_b64_tr_b16 v[134:135], v4 offset:6656
    v_mfma_f32_32x32x16_bf16 v[64:79], v[108:111], v[136:139], v[64:79]
    v_mfma_f32_32x32x16_bf16 v[80:95], v[112:115], v[136:139], v[80:95]
    s_waitcnt lgkmcnt(0)
    v_mfma_f32_32x32x16_bf16 v[16:31], v[116:119], v[140:143], v[16:31]
    ds_read_b128 v[136:139], v11
    ds_read_b64_tr_b16 v[96:97], v4 offset:10240
    ds_read_b64_tr_b16 v[98:99], v4 offset:11520
    ds_read_b64_tr_b16 v[100:101], v4 offset:10304
    v_mfma_f32_32x32x16_bf16 v[32:47], v[120:123], v[140:143], v[32:47]
    ds_read_b64_tr_b16 v[102:103], v4 offset:11584
    ds_read_b64_tr_b16 v[104:105], v4 offset:10368
    ds_read_b64_tr_b16 v[106:107], v4 offset:11648
    ds_read_b64_tr_b16 v[108:109], v4 offset:10432
    v_mfma_f32_32x32x16_bf16 v[48:63], v[124:127], v[140:143], v[48:63]
    ds_read_b64_tr_b16 v[110:111], v4 offset:11712
    ds_read_b64_tr_b16 v[112:113], v4 offset:10496
    ds_read_b64_tr_b16 v[114:115], v4 offset:11776
    v_mfma_f32_32x32x16_bf16 v[64:79], v[128:131], v[140:143], v[64:79]
    v_mfma_f32_32x32x16_bf16 v[80:95], v[132:135], v[140:143], v[80:95]
    s_waitcnt lgkmcnt(0)
    v_mfma_f32_32x32x16_bf16 v[16:31], v[96:99], v[136:139], v[16:31]
    ds_read_b128 v[140:143], v12
    ds_read_b64_tr_b16 v[116:117], v4 offset:15360
    ds_read_b64_tr_b16 v[118:119], v4 offset:16640
    ds_read_b64_tr_b16 v[120:121], v4 offset:15424
    v_mfma_f32_32x32x16_bf16 v[32:47], v[100:103], v[136:139], v[32:47]
    ds_read_b64_tr_b16 v[122:123], v4 offset:16704
    ds_read_b64_tr_b16 v[124:125], v4 offset:15488
    ds_read_b64_tr_b16 v[126:127], v4 offset:16768
    ds_read_b64_tr_b16 v[128:129], v4 offset:15552
    v_mfma_f32_32x32x16_bf16 v[48:63], v[104:107], v[136:139], v[48:63]
    ds_read_b64_tr_b16 v[130:131], v4 offset:16832
    ds_read_b64_tr_b16 v[132:133], v4 offset:15616
    ds_read_b64_tr_b16 v[134:135], v4 offset:16896
    v_mfma_f32_32x32x16_bf16 v[64:79], v[108:111], v[136:139], v[64:79]
    v_mfma_f32_32x32x16_bf16 v[80:95], v[112:115], v[136:139], v[80:95]
    v_lshlrev_b32 v1, 4, v0
    v_and_b32 v2, 31, v0
    s_lshl_b32 s64, s53, 5
    v_add_u32 v2, s64, v2
    v_lshlrev_b32 v2, 4, v2
    v_add_u32 v2, 152576, v2
    v_add_u32 v1, 110592, v1
    s_waitcnt lgkmcnt(0)
    s_barrier
    v_mfma_f32_32x32x16_bf16 v[16:31], v[116:119], v[140:143], v[16:31]
    v_mfma_f32_32x32x16_bf16 v[32:47], v[120:123], v[140:143], v[32:47]
    v_mfma_f32_32x32x16_bf16 v[48:63], v[124:127], v[140:143], v[48:63]
    v_mfma_f32_32x32x16_bf16 v[64:79], v[128:131], v[140:143], v[64:79]
    v_mfma_f32_32x32x16_bf16 v[80:95], v[132:135], v[140:143], v[80:95]
    s_barrier
    s_lshl_b32 s64, s53, 10
    v_add_u32 v144, s64, v1
    ds_read_b128 v[136:139], v144
    ds_read_b128 v[96:99], v1 offset:4096
    ds_read_b128 v[100:103], v1 offset:5120
    ds_read_b128 v[104:107], v1 offset:6144
    ds_read_b128 v[108:111], v1 offset:7168
    ds_read_b128 v[112:115], v1 offset:8192
    ds_read_b128 v[148:151], v2
    s_lshl_b32 s64, s53, 11
    v_add_u32 v145, s64, v13
    v_add_u32 v145, 119808, v145
    s_waitcnt lgkmcnt(0)
    v_mfma_f32_32x32x16_bf16 v[16:31], v[96:99], v[136:139], v[16:31]
    v_mfma_f32_32x32x16_bf16 v[32:47], v[100:103], v[136:139], v[32:47]
    v_mfma_f32_32x32x16_bf16 v[48:63], v[104:107], v[136:139], v[48:63]
    v_mfma_f32_32x32x16_bf16 v[64:79], v[108:111], v[136:139], v[64:79]
    v_mfma_f32_32x32x16_bf16 v[80:95], v[112:115], v[136:139], v[80:95]
    s_cmp_eq_u32 s63, 0
    s_cbranch_scc0 K1C_H
    v_mul_f32 v116, 0x3ea52b5c, v149
    v_mov_b32 v117, v116
    s_nop 11
    v_pk_mul_f32 v[16:17], v[16:17], v[116:117]
    v_pk_mul_f32 v[18:19], v[18:19], v[116:117]
    v_pk_mul_f32 v[20:21], v[20:21], v[116:117]
    v_pk_mul_f32 v[22:23], v[22:23], v[116:117]
    v_pk_mul_f32 v[24:25], v[24:25], v[116:117]
    v_pk_mul_f32 v[26:27], v[26:27], v[116:117]
    v_pk_mul_f32 v[28:29], v[28:29], v[116:117]
    v_pk_mul_f32 v[30:31], v[30:31], v[116:117]
    v_cvt_pk_bf16_f32 v16, v16, v17
    v_cvt_pk_bf16_f32 v17, v18, v19
    v_cvt_pk_bf16_f32 v18, v20, v21
    v_cvt_pk_bf16_f32 v19, v22, v23
    v_cvt_pk_bf16_f32 v20, v24, v25
    v_cvt_pk_bf16_f32 v21, v26, v27
    v_cvt_pk_bf16_f32 v22, v28, v29
    v_cvt_pk_bf16_f32 v23, v30, v31
    s_add_u32 s64, s62, 0
    buffer_store_dwordx4 v[16:19], v13, s[16:19], s64 offen sc0 sc1
    buffer_store_dwordx4 v[20:23], v13, s[16:19], s64 offen offset:1024 sc0 sc1
    v_pk_mul_f32 v[32:33], v[32:33], v[116:117]
    v_pk_mul_f32 v[34:35], v[34:35], v[116:117]
    v_pk_mul_f32 v[36:37], v[36:37], v[116:117]
    v_pk_mul_f32 v[38:39], v[38:39], v[116:117]
    v_pk_mul_f32 v[40:41], v[40:41], v[116:117]
    v_pk_mul_f32 v[42:43], v[42:43], v[116:117]
    v_pk_mul_f32 v[44:45], v[44:45], v[116:117]
    v_pk_mul_f32 v[46:47], v[46:47], v[116:117]
    v_cvt_pk_bf16_f32 v32, v32, v33
    v_cvt_pk_bf16_f32 v33, v34, v35
    v_cvt_pk_bf16_f32 v34, v36, v37
    v_cvt_pk_bf16_f32 v35, v38, v39
    v_cvt_pk_bf16_f32 v36, v40, v41
    v_cvt_pk_bf16_f32 v37, v42, v43
    v_cvt_pk_bf16_f32 v38, v44, v45
    v_cvt_pk_bf16_f32 v39, v46, v47
    s_add_u32 s64, s62, 2048
    buffer_store_dwordx4 v[32:35], v13, s[16:19], s64 offen sc0 sc1
    buffer_store_dwordx4 v[36:39], v13, s[16:19], s64 offen offset:1024 sc0 sc1
    v_pk_mul_f32 v[48:49], v[48:49], v[116:117]
    v_pk_mul_f32 v[50:51], v[50:51], v[116:117]
    v_pk_mul_f32 v[52:53], v[52:53], v[116:117]
    v_pk_mul_f32 v[54:55], v[54:55], v[116:117]
    v_pk_mul_f32 v[56:57], v[56:57], v[116:117]
    v_pk_mul_f32 v[58:59], v[58:59], v[116:117]
    v_pk_mul_f32 v[60:61], v[60:61], v[116:117]
    v_pk_mul_f32 v[62:63], v[62:63], v[116:117]
    v_cvt_pk_bf16_f32 v48, v48, v49
    v_cvt_pk_bf16_f32 v49, v50, v51
    v_cvt_pk_bf16_f32 v50, v52, v53
    v_cvt_pk_bf16_f32 v51, v54, v55
    v_cvt_pk_bf16_f32 v52, v56, v57
    v_cvt_pk_bf16_f32 v53, v58, v59
    v_cvt_pk_bf16_f32 v54, v60, v61
    v_cvt_pk_bf16_f32 v55, v62, v63
    s_add_u32 s64, s62, 4096
    buffer_store_dwordx4 v[48:51], v13, s[16:19], s64 offen sc0 sc1
    buffer_store_dwordx4 v[52:55], v13, s[16:19], s64 offen offset:1024 sc0 sc1
    v_pk_mul_f32 v[64:65], v[64:65], v[116:117]
    v_pk_mul_f32 v[66:67], v[66:67], v[116:117]
    v_pk_mul_f32 v[68:69], v[68:69], v[116:117]
    v_pk_mul_f32 v[70:71], v[70:71], v[116:117]
    v_pk_mul_f32 v[72:73], v[72:73], v[116:117]
    v_pk_mul_f32 v[74:75], v[74:75], v[116:117]
    v_pk_mul_f32 v[76:77], v[76:77], v[116:117]
    v_pk_mul_f32 v[78:79], v[78:79], v[116:117]
    v_cvt_pk_bf16_f32 v64, v64, v65
    v_cvt_pk_bf16_f32 v65, v66, v67
    v_cvt_pk_bf16_f32 v66, v68, v69
    v_cvt_pk_bf16_f32 v67, v70, v71
    v_cvt_pk_bf16_f32 v68, v72, v73
    v_cvt_pk_bf16_f32 v69, v74, v75
    v_cvt_pk_bf16_f32 v70, v76, v77
    v_cvt_pk_bf16_f32 v71, v78, v79
    s_add_u32 s64, s62, 6144
    buffer_store_dwordx4 v[64:67], v13, s[16:19], s64 offen sc0 sc1
    buffer_store_dwordx4 v[68:71], v13, s[16:19], s64 offen offset:1024 sc0 sc1
    v_pk_mul_f32 v[80:81], v[80:81], v[116:117]
    v_pk_mul_f32 v[82:83], v[82:83], v[116:117]
    v_pk_mul_f32 v[84:85], v[84:85], v[116:117]
    v_pk_mul_f32 v[86:87], v[86:87], v[116:117]
    v_pk_mul_f32 v[88:89], v[88:89], v[116:117]
    v_pk_mul_f32 v[90:91], v[90:91], v[116:117]
    v_pk_mul_f32 v[92:93], v[92:93], v[116:117]
    v_pk_mul_f32 v[94:95], v[94:95], v[116:117]
    v_cvt_pk_bf16_f32 v80, v80, v81
    v_cvt_pk_bf16_f32 v81, v82, v83
    v_cvt_pk_bf16_f32 v82, v84, v85
    v_cvt_pk_bf16_f32 v83, v86, v87
    v_cvt_pk_bf16_f32 v84, v88, v89
    v_cvt_pk_bf16_f32 v85, v90, v91
    v_cvt_pk_bf16_f32 v86, v92, v93
    v_cvt_pk_bf16_f32 v87, v94, v95
    s_add_u32 s64, s62, 8192
    buffer_store_dwordx4 v[80:83], v13, s[16:19], s64 offen sc0 sc1
    buffer_store_dwordx4 v[84:87], v13, s[16:19], s64 offen offset:1024 sc0 sc1
    s_endpgm
K1C_H:
    v_mul_f32 v120, 0xc0135761, v149
    v_mul_f32 v122, v149, v149
    v_mul_f32 v122, v122, v149
    v_mul_f32 v122, 0xbdd2d3e8, v122
    v_mov_b32 v121, v120
    v_mov_b32 v123, v122
    v_mov_b32 v118, v150
    v_mov_b32 v119, v150
    s_nop 7
    v_pk_mul_f32 v[124:125], v[16:17], v[16:17]
    v_pk_mul_f32 v[126:127], v[18:19], v[18:19]
    v_pk_mul_f32 v[128:129], v[20:21], v[20:21]
    v_pk_mul_f32 v[130:131], v[22:23], v[22:23]
    v_pk_fma_f32 v[124:125], v[124:125], v[122:123], v[120:121]
    v_pk_fma_f32 v[126:127], v[126:127], v[122:123], v[120:121]
    v_pk_fma_f32 v[128:129], v[128:129], v[122:123], v[120:121]
    v_pk_fma_f32 v[130:131], v[130:131], v[122:123], v[120:121]
    v_pk_mul_f32 v[124:125], v[124:125], v[16:17]
    v_pk_mul_f32 v[126:127], v[126:127], v[18:19]
    v_pk_mul_f32 v[128:129], v[128:129], v[20:21]
    v_pk_mul_f32 v[130:131], v[130:131], v[22:23]
    v_exp_f32 v124, v124
    v_exp_f32 v125, v125
    v_exp_f32 v126, v126
    v_exp_f32 v127, v127
    v_exp_f32 v128, v128
    v_exp_f32 v129, v129
    v_exp_f32 v130, v130
    v_exp_f32 v131, v131
    v_pk_fma_f32 v[124:125], v[124:125], v[118:119], v[118:119]
    v_pk_fma_f32 v[126:127], v[126:127], v[118:119], v[118:119]
    v_pk_fma_f32 v[128:129], v[128:129], v[118:119], v[118:119]
    v_pk_fma_f32 v[130:131], v[130:131], v[118:119], v[118:119]
    v_rcp_f32 v124, v124
    v_rcp_f32 v125, v125
    v_rcp_f32 v126, v126
    v_rcp_f32 v127, v127
    v_rcp_f32 v128, v128
    v_rcp_f32 v129, v129
    v_rcp_f32 v130, v130
    v_rcp_f32 v131, v131
    v_pk_mul_f32 v[16:17], v[16:17], v[124:125]
    v_pk_mul_f32 v[18:19], v[18:19], v[126:127]
    v_pk_mul_f32 v[20:21], v[20:21], v[128:129]
    v_pk_mul_f32 v[22:23], v[22:23], v[130:131]
    v_cvt_pk_bf16_f32 v16, v16, v17
    v_cvt_pk_bf16_f32 v17, v18, v19
    v_cvt_pk_bf16_f32 v18, v20, v21
    v_cvt_pk_bf16_f32 v19, v22, v23
    v_pk_mul_f32 v[124:125], v[24:25], v[24:25]
    v_pk_mul_f32 v[126:127], v[26:27], v[26:27]
    v_pk_mul_f32 v[128:129], v[28:29], v[28:29]
    v_pk_mul_f32 v[130:131], v[30:31], v[30:31]
    v_pk_fma_f32 v[124:125], v[124:125], v[122:123], v[120:121]
    v_pk_fma_f32 v[126:127], v[126:127], v[122:123], v[120:121]
    v_pk_fma_f32 v[128:129], v[128:129], v[122:123], v[120:121]
    v_pk_fma_f32 v[130:131], v[130:131], v[122:123], v[120:121]
    v_pk_mul_f32 v[124:125], v[124:125], v[24:25]
    v_pk_mul_f32 v[126:127], v[126:127], v[26:27]
    v_pk_mul_f32 v[128:129], v[128:129], v[28:29]
    v_pk_mul_f32 v[130:131], v[130:131], v[30:31]
    v_exp_f32 v124, v124
    v_exp_f32 v125, v125
    v_exp_f32 v126, v126
    v_exp_f32 v127, v127
    v_exp_f32 v128, v128
    v_exp_f32 v129, v129
    v_exp_f32 v130, v130
    v_exp_f32 v131, v131
    v_pk_fma_f32 v[124:125], v[124:125], v[118:119], v[118:119]
    v_pk_fma_f32 v[126:127], v[126:127], v[118:119], v[118:119]
    v_pk_fma_f32 v[128:129], v[128:129], v[118:119], v[118:119]
    v_pk_fma_f32 v[130:131], v[130:131], v[118:119], v[118:119]
    v_rcp_f32 v124, v124
    v_rcp_f32 v125, v125
    v_rcp_f32 v126, v126
    v_rcp_f32 v127, v127
    v_rcp_f32 v128, v128
    v_rcp_f32 v129, v129
    v_rcp_f32 v130, v130
    v_rcp_f32 v131, v131
    v_pk_mul_f32 v[24:25], v[24:25], v[124:125]
    v_pk_mul_f32 v[26:27], v[26:27], v[126:127]
    v_pk_mul_f32 v[28:29], v[28:29], v[128:129]
    v_pk_mul_f32 v[30:31], v[30:31], v[130:131]
    v_cvt_pk_bf16_f32 v20, v24, v25
    v_cvt_pk_bf16_f32 v21, v26, v27
    v_cvt_pk_bf16_f32 v22, v28, v29
    v_cvt_pk_bf16_f32 v23, v30, v31
    s_add_u32 s64, s62, 0
    buffer_store_dwordx4 v[16:19], v13, s[16:19], s64 offen sc0 sc1
    buffer_store_dwordx4 v[20:23], v13, s[16:19], s64 offen offset:1024 sc0 sc1
    v_pk_mul_f32 v[124:125], v[32:33], v[32:33]
    v_pk_mul_f32 v[126:127], v[34:35], v[34:35]
    v_pk_mul_f32 v[128:129], v[36:37], v[36:37]
    v_pk_mul_f32 v[130:131], v[38:39], v[38:39]
    v_pk_fma_f32 v[124:125], v[124:125], v[122:123], v[120:121]
    v_pk_fma_f32 v[126:127], v[126:127], v[122:123], v[120:121]
    v_pk_fma_f32 v[128:129], v[128:129], v[122:123], v[120:121]
    v_pk_fma_f32 v[130:131], v[130:131], v[122:123], v[120:121]
    v_pk_mul_f32 v[124:125], v[124:125], v[32:33]
    v_pk_mul_f32 v[126:127], v[126:127], v[34:35]
    v_pk_mul_f32 v[128:129], v[128:129], v[36:37]
    v_pk_mul_f32 v[130:131], v[130:131], v[38:39]
    v_exp_f32 v124, v124
    v_exp_f32 v125, v125
    v_exp_f32 v126, v126
    v_exp_f32 v127, v127
    v_exp_f32 v128, v128
    v_exp_f32 v129, v129
    v_exp_f32 v130, v130
    v_exp_f32 v131, v131
    v_pk_fma_f32 v[124:125], v[124:125], v[118:119], v[118:119]
    v_pk_fma_f32 v[126:127], v[126:127], v[118:119], v[118:119]
    v_pk_fma_f32 v[128:129], v[128:129], v[118:119], v[118:119]
    v_pk_fma_f32 v[130:131], v[130:131], v[118:119], v[118:119]
    v_rcp_f32 v124, v124
    v_rcp_f32 v125, v125
    v_rcp_f32 v126, v126
    v_rcp_f32 v127, v127
    v_rcp_f32 v128, v128
    v_rcp_f32 v129, v129
    v_rcp_f32 v130, v130
    v_rcp_f32 v131, v131
    v_pk_mul_f32 v[32:33], v[32:33], v[124:125]
    v_pk_mul_f32 v[34:35], v[34:35], v[126:127]
    v_pk_mul_f32 v[36:37], v[36:37], v[128:129]
    v_pk_mul_f32 v[38:39], v[38:39], v[130:131]
    v_cvt_pk_bf16_f32 v32, v32, v33
    v_cvt_pk_bf16_f32 v33, v34, v35
    v_cvt_pk_bf16_f32 v34, v36, v37
    v_cvt_pk_bf16_f32 v35, v38, v39
    v_pk_mul_f32 v[124:125], v[40:41], v[40:41]
    v_pk_mul_f32 v[126:127], v[42:43], v[42:43]
    v_pk_mul_f32 v[128:129], v[44:45], v[44:45]
    v_pk_mul_f32 v[130:131], v[46:47], v[46:47]
    v_pk_fma_f32 v[124:125], v[124:125], v[122:123], v[120:121]
    v_pk_fma_f32 v[126:127], v[126:127], v[122:123], v[120:121]
    v_pk_fma_f32 v[128:129], v[128:129], v[122:123], v[120:121]
    v_pk_fma_f32 v[130:131], v[130:131], v[122:123], v[120:121]
    v_pk_mul_f32 v[124:125], v[124:125], v[40:41]
    v_pk_mul_f32 v[126:127], v[126:127], v[42:43]
    v_pk_mul_f32 v[128:129], v[128:129], v[44:45]
    v_pk_mul_f32 v[130:131], v[130:131], v[46:47]
    v_exp_f32 v124, v124
    v_exp_f32 v125, v125
    v_exp_f32 v126, v126
    v_exp_f32 v127, v127
    v_exp_f32 v128, v128
    v_exp_f32 v129, v129
    v_exp_f32 v130, v130
    v_exp_f32 v131, v131
    v_pk_fma_f32 v[124:125], v[124:125], v[118:119], v[118:119]
    v_pk_fma_f32 v[126:127], v[126:127], v[118:119], v[118:119]
    v_pk_fma_f32 v[128:129], v[128:129], v[118:119], v[118:119]
    v_pk_fma_f32 v[130:131], v[130:131], v[118:119], v[118:119]
    v_rcp_f32 v124, v124
    v_rcp_f32 v125, v125
    v_rcp_f32 v126, v126
    v_rcp_f32 v127, v127
    v_rcp_f32 v128, v128
    v_rcp_f32 v129, v129
    v_rcp_f32 v130, v130
    v_rcp_f32 v131, v131
    v_pk_mul_f32 v[40:41], v[40:41], v[124:125]
    v_pk_mul_f32 v[42:43], v[42:43], v[126:127]
    v_pk_mul_f32 v[44:45], v[44:45], v[128:129]
    v_pk_mul_f32 v[46:47], v[46:47], v[130:131]
    v_cvt_pk_bf16_f32 v36, v40, v41
    v_cvt_pk_bf16_f32 v37, v42, v43
    v_cvt_pk_bf16_f32 v38, v44, v45
    v_cvt_pk_bf16_f32 v39, v46, v47
    s_add_u32 s64, s62, 2048
    buffer_store_dwordx4 v[32:35], v13, s[16:19], s64 offen sc0 sc1
    buffer_store_dwordx4 v[36:39], v13, s[16:19], s64 offen offset:1024 sc0 sc1
    v_pk_mul_f32 v[124:125], v[48:49], v[48:49]
    v_pk_mul_f32 v[126:127], v[50:51], v[50:51]
    v_pk_mul_f32 v[128:129], v[52:53], v[52:53]
    v_pk_mul_f32 v[130:131], v[54:55], v[54:55]
    v_pk_fma_f32 v[124:125], v[124:125], v[122:123], v[120:121]
    v_pk_fma_f32 v[126:127], v[126:127], v[122:123], v[120:121]
    v_pk_fma_f32 v[128:129], v[128:129], v[122:123], v[120:121]
    v_pk_fma_f32 v[130:131], v[130:131], v[122:123], v[120:121]
    v_pk_mul_f32 v[124:125], v[124:125], v[48:49]
    v_pk_mul_f32 v[126:127], v[126:127], v[50:51]
    v_pk_mul_f32 v[128:129], v[128:129], v[52:53]
    v_pk_mul_f32 v[130:131], v[130:131], v[54:55]
    v_exp_f32 v124, v124
    v_exp_f32 v125, v125
    v_exp_f32 v126, v126
    v_exp_f32 v127, v127
    v_exp_f32 v128, v128
    v_exp_f32 v129, v129
    v_exp_f32 v130, v130
    v_exp_f32 v131, v131
    v_pk_fma_f32 v[124:125], v[124:125], v[118:119], v[118:119]
    v_pk_fma_f32 v[126:127], v[126:127], v[118:119], v[118:119]
    v_pk_fma_f32 v[128:129], v[128:129], v[118:119], v[118:119]
    v_pk_fma_f32 v[130:131], v[130:131], v[118:119], v[118:119]
    v_rcp_f32 v124, v124
    v_rcp_f32 v125, v125
    v_rcp_f32 v126, v126
    v_rcp_f32 v127, v127
    v_rcp_f32 v128, v128
    v_rcp_f32 v129, v129
    v_rcp_f32 v130, v130
    v_rcp_f32 v131, v131
    v_pk_mul_f32 v[48:49], v[48:49], v[124:125]
    v_pk_mul_f32 v[50:51], v[50:51], v[126:127]
    v_pk_mul_f32 v[52:53], v[52:53], v[128:129]
    v_pk_mul_f32 v[54:55], v[54:55], v[130:131]
    v_cvt_pk_bf16_f32 v48, v48, v49
    v_cvt_pk_bf16_f32 v49, v50, v51
    v_cvt_pk_bf16_f32 v50, v52, v53
    v_cvt_pk_bf16_f32 v51, v54, v55
    v_pk_mul_f32 v[124:125], v[56:57], v[56:57]
    v_pk_mul_f32 v[126:127], v[58:59], v[58:59]
    v_pk_mul_f32 v[128:129], v[60:61], v[60:61]
    v_pk_mul_f32 v[130:131], v[62:63], v[62:63]
    v_pk_fma_f32 v[124:125], v[124:125], v[122:123], v[120:121]
    v_pk_fma_f32 v[126:127], v[126:127], v[122:123], v[120:121]
    v_pk_fma_f32 v[128:129], v[128:129], v[122:123], v[120:121]
    v_pk_fma_f32 v[130:131], v[130:131], v[122:123], v[120:121]
    v_pk_mul_f32 v[124:125], v[124:125], v[56:57]
    v_pk_mul_f32 v[126:127], v[126:127], v[58:59]
    v_pk_mul_f32 v[128:129], v[128:129], v[60:61]
    v_pk_mul_f32 v[130:131], v[130:131], v[62:63]
    v_exp_f32 v124, v124
    v_exp_f32 v125, v125
    v_exp_f32 v126, v126
    v_exp_f32 v127, v127
    v_exp_f32 v128, v128
    v_exp_f32 v129, v129
    v_exp_f32 v130, v130
    v_exp_f32 v131, v131
    v_pk_fma_f32 v[124:125], v[124:125], v[118:119], v[118:119]
    v_pk_fma_f32 v[126:127], v[126:127], v[118:119], v[118:119]
    v_pk_fma_f32 v[128:129], v[128:129], v[118:119], v[118:119]
    v_pk_fma_f32 v[130:131], v[130:131], v[118:119], v[118:119]
    v_rcp_f32 v124, v124
    v_rcp_f32 v125, v125
    v_rcp_f32 v126, v126
    v_rcp_f32 v127, v127
    v_rcp_f32 v128, v128
    v_rcp_f32 v129, v129
    v_rcp_f32 v130, v130
    v_rcp_f32 v131, v131
    v_pk_mul_f32 v[56:57], v[56:57], v[124:125]
    v_pk_mul_f32 v[58:59], v[58:59], v[126:127]
    v_pk_mul_f32 v[60:61], v[60:61], v[128:129]
    v_pk_mul_f32 v[62:63], v[62:63], v[130:131]
    v_cvt_pk_bf16_f32 v52, v56, v57
    v_cvt_pk_bf16_f32 v53, v58, v59
    v_cvt_pk_bf16_f32 v54, v60, v61
    v_cvt_pk_bf16_f32 v55, v62, v63
    s_add_u32 s64, s62, 4096
    buffer_store_dwordx4 v[48:51], v13, s[16:19], s64 offen sc0 sc1
    buffer_store_dwordx4 v[52:55], v13, s[16:19], s64 offen offset:1024 sc0 sc1
    v_pk_mul_f32 v[124:125], v[64:65], v[64:65]
    v_pk_mul_f32 v[126:127], v[66:67], v[66:67]
    v_pk_mul_f32 v[128:129], v[68:69], v[68:69]
    v_pk_mul_f32 v[130:131], v[70:71], v[70:71]
    v_pk_fma_f32 v[124:125], v[124:125], v[122:123], v[120:121]
    v_pk_fma_f32 v[126:127], v[126:127], v[122:123], v[120:121]
    v_pk_fma_f32 v[128:129], v[128:129], v[122:123], v[120:121]
    v_pk_fma_f32 v[130:131], v[130:131], v[122:123], v[120:121]
    v_pk_mul_f32 v[124:125], v[124:125], v[64:65]
    v_pk_mul_f32 v[126:127], v[126:127], v[66:67]
    v_pk_mul_f32 v[128:129], v[128:129], v[68:69]
    v_pk_mul_f32 v[130:131], v[130:131], v[70:71]
    v_exp_f32 v124, v124
    v_exp_f32 v125, v125
    v_exp_f32 v126, v126
    v_exp_f32 v127, v127
    v_exp_f32 v128, v128
    v_exp_f32 v129, v129
    v_exp_f32 v130, v130
    v_exp_f32 v131, v131
    v_pk_fma_f32 v[124:125], v[124:125], v[118:119], v[118:119]
    v_pk_fma_f32 v[126:127], v[126:127], v[118:119], v[118:119]
    v_pk_fma_f32 v[128:129], v[128:129], v[118:119], v[118:119]
    v_pk_fma_f32 v[130:131], v[130:131], v[118:119], v[118:119]
    v_rcp_f32 v124, v124
    v_rcp_f32 v125, v125
    v_rcp_f32 v126, v126
    v_rcp_f32 v127, v127
    v_rcp_f32 v128, v128
    v_rcp_f32 v129, v129
    v_rcp_f32 v130, v130
    v_rcp_f32 v131, v131
    v_pk_mul_f32 v[64:65], v[64:65], v[124:125]
    v_pk_mul_f32 v[66:67], v[66:67], v[126:127]
    v_pk_mul_f32 v[68:69], v[68:69], v[128:129]
    v_pk_mul_f32 v[70:71], v[70:71], v[130:131]
    v_cvt_pk_bf16_f32 v64, v64, v65
    v_cvt_pk_bf16_f32 v65, v66, v67
    v_cvt_pk_bf16_f32 v66, v68, v69
    v_cvt_pk_bf16_f32 v67, v70, v71
    v_pk_mul_f32 v[124:125], v[72:73], v[72:73]
    v_pk_mul_f32 v[126:127], v[74:75], v[74:75]
    v_pk_mul_f32 v[128:129], v[76:77], v[76:77]
    v_pk_mul_f32 v[130:131], v[78:79], v[78:79]
    v_pk_fma_f32 v[124:125], v[124:125], v[122:123], v[120:121]
    v_pk_fma_f32 v[126:127], v[126:127], v[122:123], v[120:121]
    v_pk_fma_f32 v[128:129], v[128:129], v[122:123], v[120:121]
    v_pk_fma_f32 v[130:131], v[130:131], v[122:123], v[120:121]
    v_pk_mul_f32 v[124:125], v[124:125], v[72:73]
    v_pk_mul_f32 v[126:127], v[126:127], v[74:75]
    v_pk_mul_f32 v[128:129], v[128:129], v[76:77]
    v_pk_mul_f32 v[130:131], v[130:131], v[78:79]
    v_exp_f32 v124, v124
    v_exp_f32 v125, v125
    v_exp_f32 v126, v126
    v_exp_f32 v127, v127
    v_exp_f32 v128, v128
    v_exp_f32 v129, v129
    v_exp_f32 v130, v130
    v_exp_f32 v131, v131
    v_pk_fma_f32 v[124:125], v[124:125], v[118:119], v[118:119]
    v_pk_fma_f32 v[126:127], v[126:127], v[118:119], v[118:119]
    v_pk_fma_f32 v[128:129], v[128:129], v[118:119], v[118:119]
    v_pk_fma_f32 v[130:131], v[130:131], v[118:119], v[118:119]
    v_rcp_f32 v124, v124
    v_rcp_f32 v125, v125
    v_rcp_f32 v126, v126
    v_rcp_f32 v127, v127
    v_rcp_f32 v128, v128
    v_rcp_f32 v129, v129
    v_rcp_f32 v130, v130
    v_rcp_f32 v131, v131
    v_pk_mul_f32 v[72:73], v[72:73], v[124:125]
    v_pk_mul_f32 v[74:75], v[74:75], v[126:127]
    v_pk_mul_f32 v[76:77], v[76:77], v[128:129]
    v_pk_mul_f32 v[78:79], v[78:79], v[130:131]
    v_cvt_pk_bf16_f32 v68, v72, v73
    v_cvt_pk_bf16_f32 v69, v74, v75
    v_cvt_pk_bf16_f32 v70, v76, v77
    v_cvt_pk_bf16_f32 v71, v78, v79
    s_add_u32 s64, s62, 6144
    buffer_store_dwordx4 v[64:67], v13, s[16:19], s64 offen sc0 sc1
    buffer_store_dwordx4 v[68:71], v13, s[16:19], s64 offen offset:1024 sc0 sc1
    s_cmp_eq_u32 s56, 14
    s_cbranch_scc1 K1C_done
    v_pk_mul_f32 v[124:125], v[80:81], v[80:81]
    v_pk_mul_f32 v[126:127], v[82:83], v[82:83]
    v_pk_mul_f32 v[128:129], v[84:85], v[84:85]
    v_pk_mul_f32 v[130:131], v[86:87], v[86:87]
    v_pk_fma_f32 v[124:125], v[124:125], v[122:123], v[120:121]
    v_pk_fma_f32 v[126:127], v[126:127], v[122:123], v[120:121]
    v_pk_fma_f32 v[128:129], v[128:129], v[122:123], v[120:121]
    v_pk_fma_f32 v[130:131], v[130:131], v[122:123], v[120:121]
    v_pk_mul_f32 v[124:125], v[124:125], v[80:81]
    v_pk_mul_f32 v[126:127], v[126:127], v[82:83]
    v_pk_mul_f32 v[128:129], v[128:129], v[84:85]
    v_pk_mul_f32 v[130:131], v[130:131], v[86:87]
    v_exp_f32 v124, v124
    v_exp_f32 v125, v125
    v_exp_f32 v126, v126
    v_exp_f32 v127, v127
    v_exp_f32 v128, v128
    v_exp_f32 v129, v129
    v_exp_f32 v130, v130
    v_exp_f32 v131, v131
    v_pk_fma_f32 v[124:125], v[124:125], v[118:119], v[118:119]
    v_pk_fma_f32 v[126:127], v[126:127], v[118:119], v[118:119]
    v_pk_fma_f32 v[128:129], v[128:129], v[118:119], v[118:119]
    v_pk_fma_f32 v[130:131], v[130:131], v[118:119], v[118:119]
    v_rcp_f32 v124, v124
    v_rcp_f32 v125, v125
    v_rcp_f32 v126, v126
    v_rcp_f32 v127, v127
    v_rcp_f32 v128, v128
    v_rcp_f32 v129, v129
    v_rcp_f32 v130, v130
    v_rcp_f32 v131, v131
    v_pk_mul_f32 v[80:81], v[80:81], v[124:125]
    v_pk_mul_f32 v[82:83], v[82:83], v[126:127]
    v_pk_mul_f32 v[84:85], v[84:85], v[128:129]
    v_pk_mul_f32 v[86:87], v[86:87], v[130:131]
    v_cvt_pk_bf16_f32 v80, v80, v81
    v_cvt_pk_bf16_f32 v81, v82, v83
    v_cvt_pk_bf16_f32 v82, v84, v85
    v_cvt_pk_bf16_f32 v83, v86, v87
    v_pk_mul_f32 v[124:125], v[88:89], v[88:89]
    v_pk_mul_f32 v[126:127], v[90:91], v[90:91]
    v_pk_mul_f32 v[128:129], v[92:93], v[92:93]
    v_pk_mul_f32 v[130:131], v[94:95], v[94:95]
    v_pk_fma_f32 v[124:125], v[124:125], v[122:123], v[120:121]
    v_pk_fma_f32 v[126:127], v[126:127], v[122:123], v[120:121]
    v_pk_fma_f32 v[128:129], v[128:129], v[122:123], v[120:121]
    v_pk_fma_f32 v[130:131], v[130:131], v[122:123], v[120:121]
    v_pk_mul_f32 v[124:125], v[124:125], v[88:89]
    v_pk_mul_f32 v[126:127], v[126:127], v[90:91]
    v_pk_mul_f32 v[128:129], v[128:129], v[92:93]
    v_pk_mul_f32 v[130:131], v[130:131], v[94:95]
    v_exp_f32 v124, v124
    v_exp_f32 v125, v125
    v_exp_f32 v126, v126
    v_exp_f32 v127, v127
    v_exp_f32 v128, v128
    v_exp_f32 v129, v129
    v_exp_f32 v130, v130
    v_exp_f32 v131, v131
    v_pk_fma_f32 v[124:125], v[124:125], v[118:119], v[118:119]
    v_pk_fma_f32 v[126:127], v[126:127], v[118:119], v[118:119]
    v_pk_fma_f32 v[128:129], v[128:129], v[118:119], v[118:119]
    v_pk_fma_f32 v[130:131], v[130:131], v[118:119], v[118:119]
    v_rcp_f32 v124, v124
    v_rcp_f32 v125, v125
    v_rcp_f32 v126, v126
    v_rcp_f32 v127, v127
    v_rcp_f32 v128, v128
    v_rcp_f32 v129, v129
    v_rcp_f32 v130, v130
    v_rcp_f32 v131, v131
    v_pk_mul_f32 v[88:89], v[88:89], v[124:125]
    v_pk_mul_f32 v[90:91], v[90:91], v[126:127]
    v_pk_mul_f32 v[92:93], v[92:93], v[128:129]
    v_pk_mul_f32 v[94:95], v[94:95], v[130:131]
    v_cvt_pk_bf16_f32 v84, v88, v89
    v_cvt_pk_bf16_f32 v85, v90, v91
    v_cvt_pk_bf16_f32 v86, v92, v93
    v_cvt_pk_bf16_f32 v87, v94, v95
    s_add_u32 s64, s62, 8192
    buffer_store_dwordx4 v[80:83], v13, s[16:19], s64 offen sc0 sc1
    buffer_store_dwordx4 v[84:87], v13, s[16:19], s64 offen offset:1024 sc0 sc1
K1C_done:
    s_endpgm
K1_MAIN1:
    s_mov_b32 s71, 0xffff0000
    s_setprio 0
    s_waitcnt lgkmcnt(0)
    s_mov_b32 s42, s78
    s_mov_b32 s43, s79
    s_mov_b32 s6, s76
    s_mov_b32 s7, s77
    s_mov_b32 s16, s42
    s_and_b32 s17, s43, 0xffff
    s_mov_b32 s18, 21872640
    s_mov_b32 s19, 0x20000
    s_mov_b32 s96, s6
    s_and_b32 s97, s7, 0xffff
    s_mov_b32 s98, 256
    s_mov_b32 s99, 0x20000
    s_add_u32 s20, s38, s75
    s_addc_u32 s21, s39, 0
    s_and_b32 s21, s21, 0xffff
    s_sub_u32 s22, 3456, s75
    s_cmp_eq_u32 s63, 0
    s_cselect_b32 s22, 0, s22
    s_mov_b32 s23, 0x20000
    s_cselect_b32 s64, 40, 108
    s_mov_b32 s65, 2621440
    s_cselect_b32 s65, 0, s65
    s_lshl_b32 s3, s55, 2
    s_add_u32 s3, s3, s53
    s_mul_i32 s3, s3, s64
    s_add_u32 s62, s74, s3
    s_lshl_b32 s62, s62, 10
    s_add_u32 s62, s62, s65
    v_and_b32 v1, 31, v0
    v_lshlrev_b32 v1, 1, v1
    s_lshl_b32 s3, s53, 6
    buffer_load_ushort v56, v1, s[20:23], s3 offen
    buffer_load_ushort v57, v1, s[20:23], 0 offen offset:256
    v_lshrrev_b32 v3, 5, v0
    v_mul_u32_u24 v3, 8, v3
    v_bfe_u32 v1, v0, 2, 2
    v_add_u32 v3, v3, v1
    v_mul_u32_u24 v3, 320, v3
    v_bfe_u32 v1, v0, 4, 1
    v_lshl_add_u32 v3, v1, 5, v3
    v_and_b32 v1, 3, v0
    v_lshl_add_u32 v3, v1, 3, v3
    s_mul_i32 s64, s53, 5120
    v_add_u32 v3, s64, v3
    v_mov_b32 v18, 0
    v_mov_b32 v19, 0
    v_mov_b32 v20, 0
    v_mov_b32 v21, 0
    v_mov_b32 v22, 0
    v_mov_b32 v23, 0
    v_mov_b32 v24, 0
    v_mov_b32 v25, 0
    v_mov_b32 v26, 0
    v_mov_b32 v27, 0
    s_lshl_b32 s66, s55, 4
    s_lshl_b32 s67, s55, 11
    s_add_u32 s67, s67, 20758528
    v_and_b32 v15, 3, v0
    v_lshlrev_b32 v15, 2, v15
    v_lshlrev_b32 v16, 4, v0
    s_mov_b32 s58, 0
    s_mov_b32 s69, 0
    s_cmp_eq_u32 s53, 0
    s_cselect_b32 s70, 8, 99
    s_barrier
K1A_LOOP:
    s_cmp_lg_u32 s69, s70
    s_cbranch_scc1 K1_AX0
    buffer_load_dword v17, v15, s[96:99], s66 offen sc1
K1_AX0:
    v_add_u32 v4, s58, v3
    ds_read_b64_tr_b16 v[36:37], v4 offset:0
    ds_read_b64_tr_b16 v[38:39], v4 offset:1280
    ds_read_b64_tr_b16 v[40:41], v4 offset:64
    ds_read_b64_tr_b16 v[42:43], v4 offset:1344
    ds_read_b64_tr_b16 v[44:45], v4 offset:128
    ds_read_b64_tr_b16 v[46:47], v4 offset:1408
    s_waitcnt lgkmcnt(0)
    v_lshlrev_b32 v5, 16, v36
    v_and_b32 v6, s71, v36
    v_lshlrev_b32 v7, 16, v40
    v_and_b32 v8, s71, v40
    v_lshlrev_b32 v9, 16, v44
    v_and_b32 v10, s71, v44
    v_add_f32 v18, v18, v5
    v_add_f32 v23, v23, v6
    v_add_f32 v19, v19, v7
    v_add_f32 v24, v24, v8
    v_add_f32 v20, v20, v9
    v_add_f32 v25, v25, v10
    v_lshlrev_b32 v5, 16, v37
    v_and_b32 v6, s71, v37
    v_lshlrev_b32 v7, 16, v41
    v_and_b32 v8, s71, v41
    v_lshlrev_b32 v9, 16, v45
    v_and_b32 v10, s71, v45
    v_add_f32 v18, v18, v5
    v_add_f32 v23, v23, v6
    v_add_f32 v19, v19, v7
    v_add_f32 v24, v24, v8
    v_add_f32 v20, v20, v9
    v_add_f32 v25, v25, v10
    v_lshlrev_b32 v5, 16, v38
    v_and_b32 v6, s71, v38
    v_lshlrev_b32 v7, 16, v42
    v_and_b32 v8, s71, v42
    v_lshlrev_b32 v9, 16, v46
    v_and_b32 v10, s71, v46
    v_add_f32 v18, v18, v5
    v_add_f32 v23, v23, v6
    v_add_f32 v19, v19, v7
    v_add_f32 v24, v24, v8
    v_add_f32 v20, v20, v9
    v_add_f32 v25, v25, v10
    v_lshlrev_b32 v5, 16, v39
    v_and_b32 v6, s71, v39
    v_lshlrev_b32 v7, 16, v43
    v_and_b32 v8, s71, v43
    v_lshlrev_b32 v9, 16, v47
    v_and_b32 v10, s71, v47
    v_add_f32 v18, v18, v5
    v_add_f32 v23, v23, v6
    v_add_f32 v19, v19, v7
    v_add_f32 v24, v24, v8
    v_add_f32 v20, v20, v9
    v_add_f32 v25, v25, v10
    s_cmp_lg_u32 s69, s70
    s_cbranch_scc1 K1_AX1
    s_mov_b32 s68, 0
K1_AXP:
    s_waitcnt vmcnt(0)
    v_cmp_eq_u32 vcc, 1, v17
    s_add_u32 s68, s68, 1
    s_cmp_eq_u64 vcc, -1
    s_cbranch_scc1 K1_AXG
    s_sleep 12
    buffer_load_dword v17, v15, s[96:99], s66 offen sc1
    s_cmp_lt_u32 s68, 0x10000
    s_cbranch_scc1 K1_AXP
K1_AXG:
    buffer_load_dwordx4 v[28:31], v16, s[16:19], s67 offen sc1
    buffer_load_dwordx4 v[32:35], v16, s[16:19], s67 offen offset:1024 sc1
K1_AX1:
    s_add_u32 s58, s58, 36864
    s_cmp_eq_u32 s58, 147456
    s_cselect_b32 s58, 0, s58
    s_add_u32 s69, s69, 1
    s_cmp_eq_u32 s69, 10
    s_cbranch_scc1 K1A_END
    s_barrier
    s_branch K1A_LOOP
K1A_END:
    v_add_f32 v18, v18, v23
    v_add_f32 v19, v19, v24
    v_add_f32 v20, v20, v25
    s_nop 3
    v_and_b32 v1, 31, v0
    v_lshlrev_b32 v1, 5, v1
    v_lshrrev_b32 v2, 5, v0
    v_lshl_add_u32 v1, v2, 2, v1
    s_lshl_b32 s64, s53, 3
    v_add_u32 v1, s64, v1
    v_add_u32 v1, 147456, v1
    ds_write_b32 v1, v18 offset:0
    ds_write_b32 v1, v19 offset:1024
    ds_write_b32 v1, v20 offset:2048
    s_cmp_lg_u32 s53, 0
    s_cbranch_scc1 K1_AX2
    s_waitcnt vmcnt(0)
    v_add_u32 v1, 152576, v16
    ds_write_b128 v1, v[28:31]
    ds_write_b128 v1, v[32:35] offset:1024
K1_AX2:
    s_waitcnt vmcnt(0) lgkmcnt(0)
    s_barrier
    v_and_b32 v1, 31, v0
    s_lshl_b32 s64, s53, 5
    v_add_u32 v2, s64, v1
    v_lshlrev_b32 v2, 4, v2
    v_add_u32 v2, 152576, v2
    ds_read_b128 v[28:31], v2
    v_lshlrev_b32 v1, 5, v1
    s_lshl_b32 s64, s53, 10
    v_add_u32 v2, s64, v1
    v_add_u32 v2, 147456, v2
    ds_read_b128 v[40:43], v2
    ds_read_b128 v[44:47], v2 offset:16
    v_add_u32 v1, 151552, v1
    ds_read_b128 v[48:51], v1
    ds_read_b128 v[52:55], v1 offset:16
    v_cmp_gt_u32 vcc, 32, v0
    v_lshlrev_b32 v56, 16, v56
    v_lshlrev_b32 v57, 16, v57
    v_cndmask_b32 v56, 0, v56, vcc
    v_cndmask_b32 v57, 0, v57, vcc
    s_waitcnt lgkmcnt(0)
    v_add_f32 v40, v40, v41
    v_add_f32 v42, v42, v43
    v_add_f32 v44, v44, v45
    v_add_f32 v46, v46, v47
    v_add_f32 v40, v40, v42
    v_add_f32 v44, v44, v46
    v_add_f32 v40, v40, v44
    v_cndmask_b32 v40, 0, v40, vcc
    v_add_f32 v48, v48, v49
    v_add_f32 v50, v50, v51
    v_add_f32 v52, v52, v53
    v_add_f32 v54, v54, v55
    v_add_f32 v48, v48, v50
    v_add_f32 v52, v52, v54
    v_add_f32 v48, v48, v52
    v_cndmask_b32 v48, 0, v48, vcc
    v_sub_f32 v5, 0, v28
    v_cvt_pk_bf16_f32 v8, v5, v5
    v_and_b32 v6, 0xffff0000, v8
    v_sub_f32 v7, v5, v6
    v_cvt_pk_bf16_f32 v32, v6, v7
    v_cvt_pk_bf16_f32 v8, v30, v30
    v_and_b32 v5, 0xffff0000, v8
    v_sub_f32 v7, v30, v5
    v_cvt_pk_bf16_f32 v33, v6, v5
    v_mov_b32 v35, 0
    v_cvt_pk_bf16_f32 v34, v7, v35
    v_lshlrev_b32 v16, 4, v0
    s_lshl_b32 s64, s53, 10
    v_add_u32 v1, s64, v16
    v_add_u32 v1, 110592, v1
    ds_write_b128 v1, v[32:35]
    v_cvt_pk_bf16_f32 v44, v40, v40
    v_and_b32 v5, 0xffff0000, v44
    v_sub_f32 v6, v40, v5
    v_cvt_pk_bf16_f32 v45, v6, v56
    v_mov_b32 v47, 0
    v_cvt_pk_bf16_f32 v46, v56, v47
    ds_write_b128 v1, v[44:47] offset:4096
    v_cvt_pk_bf16_f32 v52, v48, v48
    v_and_b32 v5, 0xffff0000, v52
    v_sub_f32 v6, v48, v5
    v_cvt_pk_bf16_f32 v53, v6, v57
    v_mov_b32 v55, 0
    v_cvt_pk_bf16_f32 v54, v57, v55
    v_add_u32 v2, 118784, v16
    ds_write_b128 v2, v[52:55]
    s_waitcnt lgkmcnt(0)
    s_barrier
    s_setprio 3
    s_mul_i32 s64, s2, 10240
    s_lshl_b32 s65, s53, 10
    s_add_u32 s64, s64, s65
    s_add_u32 s64, s64, 12894208
    v_mov_b32 v36, -1
    v_mov_b32 v37, -1
    v_mov_b32 v38, -1
    v_mov_b32 v39, -1
    v_lshlrev_b32 v2, 4, v0
    buffer_store_dwordx4 v[36:39], v2, s[16:19], s64 offen sc0 sc1
    s_add_u32 s64, s64, 4096
    buffer_store_dwordx4 v[36:39], v2, s[16:19], s64 offen sc0 sc1
    s_cmp_ge_u32 s53, 2
    s_cbranch_scc1 K1_NFA
    s_add_u32 s64, s64, 4096
    buffer_store_dwordx4 v[36:39], v2, s[16:19], s64 offen sc0 sc1
K1_NFA:
    s_endpgm
K1_KV:
    s_cmp_eq_u32 s54, 2
    s_cbranch_scc1 K1_LOADKV
    s_cmp_eq_u32 s54, 0
    s_cbranch_scc0 K1_KV1
    s_waitcnt lgkmcnt(0)
    s_mov_b32 s42, s78
    s_mov_b32 s43, s79
    s_mov_b32 s6, s76
    s_mov_b32 s7, s77
    s_mov_b32 s8, s24
    s_and_b32 s9, s25, 0xffff
    s_mov_b32 s10, 2621440
    s_mov_b32 s11, 0x20000
    s_mov_b32 s16, s42
    s_and_b32 s17, s43, 0xffff
    s_mov_b32 s18, 21872640
    s_mov_b32 s19, 0x20000
    s_mov_b32 s96, s6
    s_and_b32 s97, s7, 0xffff
    s_mov_b32 s98, 256
    s_mov_b32 s99, 0x20000
    s_lshl_b32 s3, s55, 2
    s_add_u32 s3, s3, s53
    s_mul_i32 s62, s3, 2560
    s_add_u32 s62, s62, 9699328
    v_lshlrev_b32 v12, 4, v0
    v_lshrrev_b32 v3, 5, v0
    v_mul_u32_u24 v3, 8, v3
    v_bfe_u32 v1, v0, 2, 2
    v_add_u32 v3, v3, v1
    v_mul_u32_u24 v3, 40, v3
    v_bfe_u32 v1, v0, 4, 1
    v_lshl_add_u32 v3, v1, 5, v3
    v_and_b32 v1, 3, v0
    v_lshl_add_u32 v3, v1, 3, v3
    v_add_u32 v3, 0, v3
    v_and_b32 v1, 31, v0
    v_bfe_u32 v2, v0, 1, 3
    v_lshrrev_b32 v4, 5, v0
    v_xor_b32 v2, v2, v4
    v_lshlrev_b32 v2, 4, v2
    s_lshl_b32 s64, s53, 5
    v_add_u32 v1, s64, v1
    v_lshlrev_b32 v1, 7, v1
    v_add_u32 v1, v1, v2
    v_add_u32 v4, 20480, v1
    v_xor_b32 v5, 32, v4
    v_xor_b32 v6, 64, v4
    v_xor_b32 v7, 96, v4
    v_add_u32 v8, 73728, v4
    v_add_u32 v9, 73728, v5
    v_add_u32 v10, 73728, v6
    v_add_u32 v11, 73728, v7
    v_mov_b32 v13, 0x3f803f80
    v_mov_b32 v14, 0
    v_mov_b32 v15, 0
    v_mov_b32 v16, 0
    v_mov_b32 v17, 0
    v_mov_b32 v18, 0
    v_mov_b32 v19, 0
    v_mov_b32 v20, 0
    v_mov_b32 v21, 0
    v_mov_b32 v22, 0
    v_mov_b32 v24, 0
    v_mov_b32 v25, 0
    v_mov_b32 v26, 0
    v_mov_b32 v27, 0
    v_mov_b32 v28, 0
    v_mov_b32 v29, 0
    v_mov_b32 v30, 0
    v_mov_b32 v31, 0
    v_mov_b32 v32, 0
    v_mov_b32 v33, 0
    v_mov_b32 v34, 0
    v_mov_b32 v35, 0
    v_mov_b32 v36, 0
    v_mov_b32 v37, 0
    v_mov_b32 v38, 0
    v_mov_b32 v39, 0
    s_setprio 3
    s_lshl_b32 s64, s55, 7
    s_lshl_b32 s65, s53, 5
    s_add_u32 s64, s64, s65
    v_lshrrev_b32 v144, 3, v0
    v_add_u32 v144, s64, v144
    v_mul_u32_u24 v144, 1280, v144
    v_and_b32 v1, 7, v0
    v_lshl_add_u32 v144, v1, 4, v144
    s_mov_b32 s65, 0
    buffer_load_dwordx4 v[64:67], v144, s[8:11], s65 offen
    s_mov_b32 s65, 128
    buffer_load_dwordx4 v[68:71], v144, s[8:11], s65 offen
    s_mov_b32 s65, 256
    buffer_load_dwordx4 v[72:75], v144, s[8:11], s65 offen
    s_mov_b32 s65, 384
    buffer_load_dwordx4 v[76:79], v144, s[8:11], s65 offen
    s_mov_b32 s65, 512
    buffer_load_dwordx4 v[80:83], v144, s[8:11], s65 offen
    s_mov_b32 s65, 640
    buffer_load_dwordx4 v[84:87], v144, s[8:11], s65 offen
    s_mov_b32 s65, 768
    buffer_load_dwordx4 v[88:91], v144, s[8:11], s65 offen
    s_mov_b32 s65, 896
    buffer_load_dwordx4 v[92:95], v144, s[8:11], s65 offen
    s_mov_b32 s65, 1024
    buffer_load_dwordx4 v[96:99], v144, s[8:11], s65 offen
    s_mov_b32 s65, 1152
    buffer_load_dwordx4 v[100:103], v144, s[8:11], s65 offen
    s_mov_b32 s65, 10240
    buffer_load_dwordx4 v[104:107], v144, s[8:11], s65 offen
    s_mov_b32 s65, 10368
    buffer_load_dwordx4 v[108:111], v144, s[8:11], s65 offen
    s_mov_b32 s65, 10496
    buffer_load_dwordx4 v[112:115], v144, s[8:11], s65 offen
    s_mov_b32 s65, 10624
    buffer_load_dwordx4 v[116:119], v144, s[8:11], s65 offen
    s_mov_b32 s65, 10752
    buffer_load_dwordx4 v[120:123], v144, s[8:11], s65 offen
    s_mov_b32 s65, 10880
    buffer_load_dwordx4 v[124:127], v144, s[8:11], s65 offen
    s_mov_b32 s65, 11008
    buffer_load_dwordx4 v[128:131], v144, s[8:11], s65 offen
    s_mov_b32 s65, 11136
    buffer_load_dwordx4 v[132:135], v144, s[8:11], s65 offen
    s_mov_b32 s65, 11264
    buffer_load_dwordx4 v[136:139], v144, s[8:11], s65 offen
    s_mov_b32 s65, 11392
    buffer_load_dwordx4 v[140:143], v144, s[8:11], s65 offen
    v_mov_b32 v145, 0
    v_mov_b32 v146, 0
    v_mov_b32 v147, 0
    v_mov_b32 v148, 0
    v_mov_b32 v149, 0
    v_mov_b32 v150, 0
    v_mov_b32 v151, 0
    v_mov_b32 v152, 0
    s_waitcnt vmcnt(10)
    v_dot2_f32_bf16 v145, v64, v13, v145
    v_dot2_f32_bf16 v146, v64, v64, v146
    v_dot2_f32_bf16 v145, v65, v13, v145
    v_dot2_f32_bf16 v146, v65, v65, v146
    v_dot2_f32_bf16 v145, v66, v13, v145
    v_dot2_f32_bf16 v146, v66, v66, v146
    v_dot2_f32_bf16 v145, v67, v13, v145
    v_dot2_f32_bf16 v146, v67, v67, v146
    v_dot2_f32_bf16 v145, v68, v13, v145
    v_dot2_f32_bf16 v146, v68, v68, v146
    v_dot2_f32_bf16 v145, v69, v13, v145
    v_dot2_f32_bf16 v146, v69, v69, v146
    v_dot2_f32_bf16 v145, v70, v13, v145
    v_dot2_f32_bf16 v146, v70, v70, v146
    v_dot2_f32_bf16 v145, v71, v13, v145
    v_dot2_f32_bf16 v146, v71, v71, v146
    v_dot2_f32_bf16 v145, v72, v13, v145
    v_dot2_f32_bf16 v146, v72, v72, v146
    v_dot2_f32_bf16 v145, v73, v13, v145
    v_dot2_f32_bf16 v146, v73, v73, v146
    v_dot2_f32_bf16 v145, v74, v13, v145
    v_dot2_f32_bf16 v146, v74, v74, v146
    v_dot2_f32_bf16 v145, v75, v13, v145
    v_dot2_f32_bf16 v146, v75, v75, v146
    v_dot2_f32_bf16 v145, v76, v13, v145
    v_dot2_f32_bf16 v146, v76, v76, v146
    v_dot2_f32_bf16 v145, v77, v13, v145
    v_dot2_f32_bf16 v146, v77, v77, v146
    v_dot2_f32_bf16 v145, v78, v13, v145
    v_dot2_f32_bf16 v146, v78, v78, v146
    v_dot2_f32_bf16 v145, v79, v13, v145
    v_dot2_f32_bf16 v146, v79, v79, v146
    v_dot2_f32_bf16 v145, v80, v13, v145
    v_dot2_f32_bf16 v146, v80, v80, v146
    v_dot2_f32_bf16 v145, v81, v13, v145
    v_dot2_f32_bf16 v146, v81, v81, v146
    v_dot2_f32_bf16 v145, v82, v13, v145
    v_dot2_f32_bf16 v146, v82, v82, v146
    v_dot2_f32_bf16 v145, v83, v13, v145
    v_dot2_f32_bf16 v146, v83, v83, v146
    v_dot2_f32_bf16 v145, v84, v13, v145
    v_dot2_f32_bf16 v146, v84, v84, v146
    v_dot2_f32_bf16 v145, v85, v13, v145
    v_dot2_f32_bf16 v146, v85, v85, v146
    v_dot2_f32_bf16 v145, v86, v13, v145
    v_dot2_f32_bf16 v146, v86, v86, v146
    v_dot2_f32_bf16 v145, v87, v13, v145
    v_dot2_f32_bf16 v146, v87, v87, v146
    v_dot2_f32_bf16 v145, v88, v13, v145
    v_dot2_f32_bf16 v146, v88, v88, v146
    v_dot2_f32_bf16 v145, v89, v13, v145
    v_dot2_f32_bf16 v146, v89, v89, v146
    v_dot2_f32_bf16 v145, v90, v13, v145
    v_dot2_f32_bf16 v146, v90, v90, v146
    v_dot2_f32_bf16 v145, v91, v13, v145
    v_dot2_f32_bf16 v146, v91, v91, v146
    v_dot2_f32_bf16 v145, v92, v13, v145
    v_dot2_f32_bf16 v146, v92, v92, v146
    v_dot2_f32_bf16 v145, v93, v13, v145
    v_dot2_f32_bf16 v146, v93, v93, v146
    v_dot2_f32_bf16 v145, v94, v13, v145
    v_dot2_f32_bf16 v146, v94, v94, v146
    v_dot2_f32_bf16 v145, v95, v13, v145
    v_dot2_f32_bf16 v146, v95, v95, v146
    v_dot2_f32_bf16 v145, v96, v13, v145
    v_dot2_f32_bf16 v146, v96, v96, v146
    v_dot2_f32_bf16 v145, v97, v13, v145
    v_dot2_f32_bf16 v146, v97, v97, v146
    v_dot2_f32_bf16 v145, v98, v13, v145
    v_dot2_f32_bf16 v146, v98, v98, v146
    v_dot2_f32_bf16 v145, v99, v13, v145
    v_dot2_f32_bf16 v146, v99, v99, v146
    v_dot2_f32_bf16 v145, v100, v13, v145
    v_dot2_f32_bf16 v146, v100, v100, v146
    v_dot2_f32_bf16 v145, v101, v13, v145
    v_dot2_f32_bf16 v146, v101, v101, v146
    v_dot2_f32_bf16 v145, v102, v13, v145
    v_dot2_f32_bf16 v146, v102, v102, v146
    v_dot2_f32_bf16 v145, v103, v13, v145
    v_dot2_f32_bf16 v146, v103, v103, v146
    s_mov_b32 s65, 20480
    buffer_load_dwordx4 v[64:67], v144, s[8:11], s65 offen
    s_mov_b32 s65, 20608
    buffer_load_dwordx4 v[68:71], v144, s[8:11], s65 offen
    s_mov_b32 s65, 20736
    buffer_load_dwordx4 v[72:75], v144, s[8:11], s65 offen
    s_mov_b32 s65, 20864
    buffer_load_dwordx4 v[76:79], v144, s[8:11], s65 offen
    s_mov_b32 s65, 20992
    buffer_load_dwordx4 v[80:83], v144, s[8:11], s65 offen
    s_mov_b32 s65, 21120
    buffer_load_dwordx4 v[84:87], v144, s[8:11], s65 offen
    s_mov_b32 s65, 21248
    buffer_load_dwordx4 v[88:91], v144, s[8:11], s65 offen
    s_mov_b32 s65, 21376
    buffer_load_dwordx4 v[92:95], v144, s[8:11], s65 offen
    s_mov_b32 s65, 21504
    buffer_load_dwordx4 v[96:99], v144, s[8:11], s65 offen
    s_mov_b32 s65, 21632
    buffer_load_dwordx4 v[100:103], v144, s[8:11], s65 offen
    s_waitcnt vmcnt(10)
    v_dot2_f32_bf16 v147, v104, v13, v147
    v_dot2_f32_bf16 v148, v104, v104, v148
    v_dot2_f32_bf16 v147, v105, v13, v147
    v_dot2_f32_bf16 v148, v105, v105, v148
    v_dot2_f32_bf16 v147, v106, v13, v147
    v_dot2_f32_bf16 v148, v106, v106, v148
    v_dot2_f32_bf16 v147, v107, v13, v147
    v_dot2_f32_bf16 v148, v107, v107, v148
    v_dot2_f32_bf16 v147, v108, v13, v147
    v_dot2_f32_bf16 v148, v108, v108, v148
    v_dot2_f32_bf16 v147, v109, v13, v147
    v_dot2_f32_bf16 v148, v109, v109, v148
    v_dot2_f32_bf16 v147, v110, v13, v147
    v_dot2_f32_bf16 v148, v110, v110, v148
    v_dot2_f32_bf16 v147, v111, v13, v147
    v_dot2_f32_bf16 v148, v111, v111, v148
    v_dot2_f32_bf16 v147, v112, v13, v147
    v_dot2_f32_bf16 v148, v112, v112, v148
    v_dot2_f32_bf16 v147, v113, v13, v147
    v_dot2_f32_bf16 v148, v113, v113, v148
    v_dot2_f32_bf16 v147, v114, v13, v147
    v_dot2_f32_bf16 v148, v114, v114, v148
    v_dot2_f32_bf16 v147, v115, v13, v147
    v_dot2_f32_bf16 v148, v115, v115, v148
    v_dot2_f32_bf16 v147, v116, v13, v147
    v_dot2_f32_bf16 v148, v116, v116, v148
    v_dot2_f32_bf16 v147, v117, v13, v147
    v_dot2_f32_bf16 v148, v117, v117, v148
    v_dot2_f32_bf16 v147, v118, v13, v147
    v_dot2_f32_bf16 v148, v118, v118, v148
    v_dot2_f32_bf16 v147, v119, v13, v147
    v_dot2_f32_bf16 v148, v119, v119, v148
    v_dot2_f32_bf16 v147, v120, v13, v147
    v_dot2_f32_bf16 v148, v120, v120, v148
    v_dot2_f32_bf16 v147, v121, v13, v147
    v_dot2_f32_bf16 v148, v121, v121, v148
    v_dot2_f32_bf16 v147, v122, v13, v147
    v_dot2_f32_bf16 v148, v122, v122, v148
    v_dot2_f32_bf16 v147, v123, v13, v147
    v_dot2_f32_bf16 v148, v123, v123, v148
    v_dot2_f32_bf16 v147, v124, v13, v147
    v_dot2_f32_bf16 v148, v124, v124, v148
    v_dot2_f32_bf16 v147, v125, v13, v147
    v_dot2_f32_bf16 v148, v125, v125, v148
    v_dot2_f32_bf16 v147, v126, v13, v147
    v_dot2_f32_bf16 v148, v126, v126, v148
    v_dot2_f32_bf16 v147, v127, v13, v147
    v_dot2_f32_bf16 v148, v127, v127, v148
    v_dot2_f32_bf16 v147, v128, v13, v147
    v_dot2_f32_bf16 v148, v128, v128, v148
    v_dot2_f32_bf16 v147, v129, v13, v147
    v_dot2_f32_bf16 v148, v129, v129, v148
    v_dot2_f32_bf16 v147, v130, v13, v147
    v_dot2_f32_bf16 v148, v130, v130, v148
    v_dot2_f32_bf16 v147, v131, v13, v147
    v_dot2_f32_bf16 v148, v131, v131, v148
    v_dot2_f32_bf16 v147, v132, v13, v147
    v_dot2_f32_bf16 v148, v132, v132, v148
    v_dot2_f32_bf16 v147, v133, v13, v147
    v_dot2_f32_bf16 v148, v133, v133, v148
    v_dot2_f32_bf16 v147, v134, v13, v147
    v_dot2_f32_bf16 v148, v134, v134, v148
    v_dot2_f32_bf16 v147, v135, v13, v147
    v_dot2_f32_bf16 v148, v135, v135, v148
    v_dot2_f32_bf16 v147, v136, v13, v147
    v_dot2_f32_bf16 v148, v136, v136, v148
    v_dot2_f32_bf16 v147, v137, v13, v147
    v_dot2_f32_bf16 v148, v137, v137, v148
    v_dot2_f32_bf16 v147, v138, v13, v147
    v_dot2_f32_bf16 v148, v138, v138, v148
    v_dot2_f32_bf16 v147, v139, v13, v147
    v_dot2_f32_bf16 v148, v139, v139, v148
    v_dot2_f32_bf16 v147, v140, v13, v147
    v_dot2_f32_bf16 v148, v140, v140, v148
    v_dot2_f32_bf16 v147, v141, v13, v147
    v_dot2_f32_bf16 v148, v141, v141, v148
    v_dot2_f32_bf16 v147, v142, v13, v147
    v_dot2_f32_bf16 v148, v142, v142, v148
    v_dot2_f32_bf16 v147, v143, v13, v147
    v_dot2_f32_bf16 v148, v143, v143, v148
    s_mov_b32 s65, 30720
    buffer_load_dwordx4 v[104:107], v144, s[8:11], s65 offen
    s_mov_b32 s65, 30848
    buffer_load_dwordx4 v[108:111], v144, s[8:11], s65 offen
    s_mov_b32 s65, 30976
    buffer_load_dwordx4 v[112:115], v144, s[8:11], s65 offen
    s_mov_b32 s65, 31104
    buffer_load_dwordx4 v[116:119], v144, s[8:11], s65 offen
    s_mov_b32 s65, 31232
    buffer_load_dwordx4 v[120:123], v144, s[8:11], s65 offen
    s_mov_b32 s65, 31360
    buffer_load_dwordx4 v[124:127], v144, s[8:11], s65 offen
    s_mov_b32 s65, 31488
    buffer_load_dwordx4 v[128:131], v144, s[8:11], s65 offen
    s_mov_b32 s65, 31616
    buffer_load_dwordx4 v[132:135], v144, s[8:11], s65 offen
    s_mov_b32 s65, 31744
    buffer_load_dwordx4 v[136:139], v144, s[8:11], s65 offen
    s_mov_b32 s65, 31872
    buffer_load_dwordx4 v[140:143], v144, s[8:11], s65 offen
    s_waitcnt vmcnt(10)
    v_dot2_f32_bf16 v149, v64, v13, v149
    v_dot2_f32_bf16 v150, v64, v64, v150
    v_dot2_f32_bf16 v149, v65, v13, v149
    v_dot2_f32_bf16 v150, v65, v65, v150
    v_dot2_f32_bf16 v149, v66, v13, v149
    v_dot2_f32_bf16 v150, v66, v66, v150
    v_dot2_f32_bf16 v149, v67, v13, v149
    v_dot2_f32_bf16 v150, v67, v67, v150
    v_dot2_f32_bf16 v149, v68, v13, v149
    v_dot2_f32_bf16 v150, v68, v68, v150
    v_dot2_f32_bf16 v149, v69, v13, v149
    v_dot2_f32_bf16 v150, v69, v69, v150
    v_dot2_f32_bf16 v149, v70, v13, v149
    v_dot2_f32_bf16 v150, v70, v70, v150
    v_dot2_f32_bf16 v149, v71, v13, v149
    v_dot2_f32_bf16 v150, v71, v71, v150
    v_dot2_f32_bf16 v149, v72, v13, v149
    v_dot2_f32_bf16 v150, v72, v72, v150
    v_dot2_f32_bf16 v149, v73, v13, v149
    v_dot2_f32_bf16 v150, v73, v73, v150
    v_dot2_f32_bf16 v149, v74, v13, v149
    v_dot2_f32_bf16 v150, v74, v74, v150
    v_dot2_f32_bf16 v149, v75, v13, v149
    v_dot2_f32_bf16 v150, v75, v75, v150
    v_dot2_f32_bf16 v149, v76, v13, v149
    v_dot2_f32_bf16 v150, v76, v76, v150
    v_dot2_f32_bf16 v149, v77, v13, v149
    v_dot2_f32_bf16 v150, v77, v77, v150
    v_dot2_f32_bf16 v149, v78, v13, v149
    v_dot2_f32_bf16 v150, v78, v78, v150
    v_dot2_f32_bf16 v149, v79, v13, v149
    v_dot2_f32_bf16 v150, v79, v79, v150
    v_dot2_f32_bf16 v149, v80, v13, v149
    v_dot2_f32_bf16 v150, v80, v80, v150
    v_dot2_f32_bf16 v149, v81, v13, v149
    v_dot2_f32_bf16 v150, v81, v81, v150
    v_dot2_f32_bf16 v149, v82, v13, v149
    v_dot2_f32_bf16 v150, v82, v82, v150
    v_dot2_f32_bf16 v149, v83, v13, v149
    v_dot2_f32_bf16 v150, v83, v83, v150
    v_dot2_f32_bf16 v149, v84, v13, v149
    v_dot2_f32_bf16 v150, v84, v84, v150
    v_dot2_f32_bf16 v149, v85, v13, v149
    v_dot2_f32_bf16 v150, v85, v85, v150
    v_dot2_f32_bf16 v149, v86, v13, v149
    v_dot2_f32_bf16 v150, v86, v86, v150
    v_dot2_f32_bf16 v149, v87, v13, v149
    v_dot2_f32_bf16 v150, v87, v87, v150
    v_dot2_f32_bf16 v149, v88, v13, v149
    v_dot2_f32_bf16 v150, v88, v88, v150
    v_dot2_f32_bf16 v149, v89, v13, v149
    v_dot2_f32_bf16 v150, v89, v89, v150
    v_dot2_f32_bf16 v149, v90, v13, v149
    v_dot2_f32_bf16 v150, v90, v90, v150
    v_dot2_f32_bf16 v149, v91, v13, v149
    v_dot2_f32_bf16 v150, v91, v91, v150
    v_dot2_f32_bf16 v149, v92, v13, v149
    v_dot2_f32_bf16 v150, v92, v92, v150
    v_dot2_f32_bf16 v149, v93, v13, v149
    v_dot2_f32_bf16 v150, v93, v93, v150
    v_dot2_f32_bf16 v149, v94, v13, v149
    v_dot2_f32_bf16 v150, v94, v94, v150
    v_dot2_f32_bf16 v149, v95, v13, v149
    v_dot2_f32_bf16 v150, v95, v95, v150
    v_dot2_f32_bf16 v149, v96, v13, v149
    v_dot2_f32_bf16 v150, v96, v96, v150
    v_dot2_f32_bf16 v149, v97, v13, v149
    v_dot2_f32_bf16 v150, v97, v97, v150
    v_dot2_f32_bf16 v149, v98, v13, v149
    v_dot2_f32_bf16 v150, v98, v98, v150
    v_dot2_f32_bf16 v149, v99, v13, v149
    v_dot2_f32_bf16 v150, v99, v99, v150
    v_dot2_f32_bf16 v149, v100, v13, v149
    v_dot2_f32_bf16 v150, v100, v100, v150
    v_dot2_f32_bf16 v149, v101, v13, v149
    v_dot2_f32_bf16 v150, v101, v101, v150
    v_dot2_f32_bf16 v149, v102, v13, v149
    v_dot2_f32_bf16 v150, v102, v102, v150
    v_dot2_f32_bf16 v149, v103, v13, v149
    v_dot2_f32_bf16 v150, v103, v103, v150
    s_waitcnt vmcnt(0)
    v_dot2_f32_bf16 v151, v104, v13, v151
    v_dot2_f32_bf16 v152, v104, v104, v152
    v_dot2_f32_bf16 v151, v105, v13, v151
    v_dot2_f32_bf16 v152, v105, v105, v152
    v_dot2_f32_bf16 v151, v106, v13, v151
    v_dot2_f32_bf16 v152, v106, v106, v152
    v_dot2_f32_bf16 v151, v107, v13, v151
    v_dot2_f32_bf16 v152, v107, v107, v152
    v_dot2_f32_bf16 v151, v108, v13, v151
    v_dot2_f32_bf16 v152, v108, v108, v152
    v_dot2_f32_bf16 v151, v109, v13, v151
    v_dot2_f32_bf16 v152, v109, v109, v152
    v_dot2_f32_bf16 v151, v110, v13, v151
    v_dot2_f32_bf16 v152, v110, v110, v152
    v_dot2_f32_bf16 v151, v111, v13, v151
    v_dot2_f32_bf16 v152, v111, v111, v152
    v_dot2_f32_bf16 v151, v112, v13, v151
    v_dot2_f32_bf16 v152, v112, v112, v152
    v_dot2_f32_bf16 v151, v113, v13, v151
    v_dot2_f32_bf16 v152, v113, v113, v152
    v_dot2_f32_bf16 v151, v114, v13, v151
    v_dot2_f32_bf16 v152, v114, v114, v152
    v_dot2_f32_bf16 v151, v115, v13, v151
    v_dot2_f32_bf16 v152, v115, v115, v152
    v_dot2_f32_bf16 v151, v116, v13, v151
    v_dot2_f32_bf16 v152, v116, v116, v152
    v_dot2_f32_bf16 v151, v117, v13, v151
    v_dot2_f32_bf16 v152, v117, v117, v152
    v_dot2_f32_bf16 v151, v118, v13, v151
    v_dot2_f32_bf16 v152, v118, v118, v152
    v_dot2_f32_bf16 v151, v119, v13, v151
    v_dot2_f32_bf16 v152, v119, v119, v152
    v_dot2_f32_bf16 v151, v120, v13, v151
    v_dot2_f32_bf16 v152, v120, v120, v152
    v_dot2_f32_bf16 v151, v121, v13, v151
    v_dot2_f32_bf16 v152, v121, v121, v152
    v_dot2_f32_bf16 v151, v122, v13, v151
    v_dot2_f32_bf16 v152, v122, v122, v152
    v_dot2_f32_bf16 v151, v123, v13, v151
    v_dot2_f32_bf16 v152, v123, v123, v152
    v_dot2_f32_bf16 v151, v124, v13, v151
    v_dot2_f32_bf16 v152, v124, v124, v152
    v_dot2_f32_bf16 v151, v125, v13, v151
    v_dot2_f32_bf16 v152, v125, v125, v152
    v_dot2_f32_bf16 v151, v126, v13, v151
    v_dot2_f32_bf16 v152, v126, v126, v152
    v_dot2_f32_bf16 v151, v127, v13, v151
    v_dot2_f32_bf16 v152, v127, v127, v152
    v_dot2_f32_bf16 v151, v128, v13, v151
    v_dot2_f32_bf16 v152, v128, v128, v152
    v_dot2_f32_bf16 v151, v129, v13, v151
    v_dot2_f32_bf16 v152, v129, v129, v152
    v_dot2_f32_bf16 v151, v130, v13, v151
    v_dot2_f32_bf16 v152, v130, v130, v152
    v_dot2_f32_bf16 v151, v131, v13, v151
    v_dot2_f32_bf16 v152, v131, v131, v152
    v_dot2_f32_bf16 v151, v132, v13, v151
    v_dot2_f32_bf16 v152, v132, v132, v152
    v_dot2_f32_bf16 v151, v133, v13, v151
    v_dot2_f32_bf16 v152, v133, v133, v152
    v_dot2_f32_bf16 v151, v134, v13, v151
    v_dot2_f32_bf16 v152, v134, v134, v152
    v_dot2_f32_bf16 v151, v135, v13, v151
    v_dot2_f32_bf16 v152, v135, v135, v152
    v_dot2_f32_bf16 v151, v136, v13, v151
    v_dot2_f32_bf16 v152, v136, v136, v152
    v_dot2_f32_bf16 v151, v137, v13, v151
    v_dot2_f32_bf16 v152, v137, v137, v152
    v_dot2_f32_bf16 v151, v138, v13, v151
    v_dot2_f32_bf16 v152, v138, v138, v152
    v_dot2_f32_bf16 v151, v139, v13, v151
    v_dot2_f32_bf16 v152, v139, v139, v152
    v_dot2_f32_bf16 v151, v140, v13, v151
    v_dot2_f32_bf16 v152, v140, v140, v152
    v_dot2_f32_bf16 v151, v141, v13, v151
    v_dot2_f32_bf16 v152, v141, v141, v152
    v_dot2_f32_bf16 v151, v142, v13, v151
    v_dot2_f32_bf16 v152, v142, v142, v152
    v_dot2_f32_bf16 v151, v143, v13, v151
    v_dot2_f32_bf16 v152, v143, v143, v152
    s_nop 3
    v_add_f32_dpp v145, v145, v145 quad_perm:[1,0,3,2] row_mask:0xf bank_mask:0xf
    v_add_f32_dpp v146, v146, v146 quad_perm:[1,0,3,2] row_mask:0xf bank_mask:0xf
    v_add_f32_dpp v147, v147, v147 quad_perm:[1,0,3,2] row_mask:0xf bank_mask:0xf
    v_add_f32_dpp v148, v148, v148 quad_perm:[1,0,3,2] row_mask:0xf bank_mask:0xf
    v_add_f32_dpp v149, v149, v149 quad_perm:[1,0,3,2] row_mask:0xf bank_mask:0xf
    v_add_f32_dpp v150, v150, v150 quad_perm:[1,0,3,2] row_mask:0xf bank_mask:0xf
    v_add_f32_dpp v151, v151, v151 quad_perm:[1,0,3,2] row_mask:0xf bank_mask:0xf
    v_add_f32_dpp v152, v152, v152 quad_perm:[1,0,3,2] row_mask:0xf bank_mask:0xf
    s_nop 1
    v_add_f32_dpp v145, v145, v145 quad_perm:[2,3,0,1] row_mask:0xf bank_mask:0xf
    v_add_f32_dpp v146, v146, v146 quad_perm:[2,3,0,1] row_mask:0xf bank_mask:0xf
    v_add_f32_dpp v147, v147, v147 quad_perm:[2,3,0,1] row_mask:0xf bank_mask:0xf
    v_add_f32_dpp v148, v148, v148 quad_perm:[2,3,0,1] row_mask:0xf bank_mask:0xf
    v_add_f32_dpp v149, v149, v149 quad_perm:[2,3,0,1] row_mask:0xf bank_mask:0xf
    v_add_f32_dpp v150, v150, v150 quad_perm:[2,3,0,1] row_mask:0xf bank_mask:0xf
    v_add_f32_dpp v151, v151, v151 quad_perm:[2,3,0,1] row_mask:0xf bank_mask:0xf
    v_add_f32_dpp v152, v152, v152 quad_perm:[2,3,0,1] row_mask:0xf bank_mask:0xf
    s_nop 1
    v_add_f32_dpp v145, v145, v145 row_half_mirror row_mask:0xf bank_mask:0xf
    v_add_f32_dpp v146, v146, v146 row_half_mirror row_mask:0xf bank_mask:0xf
    v_add_f32_dpp v147, v147, v147 row_half_mirror row_mask:0xf bank_mask:0xf
    v_add_f32_dpp v148, v148, v148 row_half_mirror row_mask:0xf bank_mask:0xf
    v_add_f32_dpp v149, v149, v149 row_half_mirror row_mask:0xf bank_mask:0xf
    v_add_f32_dpp v150, v150, v150 row_half_mirror row_mask:0xf bank_mask:0xf
    v_add_f32_dpp v151, v151, v151 row_half_mirror row_mask:0xf bank_mask:0xf
    v_add_f32_dpp v152, v152, v152 row_half_mirror row_mask:0xf bank_mask:0xf
    s_nop 1
    v_and_b32 v1, 7, v0
    v_cmp_eq_u32 vcc, 1, v1
    s_nop 1
    v_cndmask_b32 v145, v145, v147, vcc
    v_cndmask_b32 v146, v146, v148, vcc
    v_cmp_eq_u32 vcc, 2, v1
    s_nop 1
    v_cndmask_b32 v145, v145, v149, vcc
    v_cndmask_b32 v146, v146, v150, vcc
    v_cmp_eq_u32 vcc, 3, v1
    s_nop 1
    v_cndmask_b32 v145, v145, v151, vcc
    v_cndmask_b32 v146, v146, v152, vcc
    v_mul_f32 v56, 0x3acccccd, v145
    v_mul_f32 v146, 0x3acccccd, v146
    v_fma_f32 v146, -v56, v56, v146
    v_max_f32 v146, 0, v146
    v_add_f32 v146, 0x3727c5ac, v146
    v_rsq_f32 v57, v146
    s_nop 0
    v_mul_f32 v58, v146, v57
    v_mov_b32 v59, 0
    v_lshlrev_b32 v2, 3, v1
    v_lshrrev_b32 v144, 3, v0
    v_add_u32 v2, v2, v144
    v_lshlrev_b32 v2, 4, v2
    s_lshl_b32 s64, s55, 2
    s_add_u32 s64, s64, s53
    s_lshl_b32 s65, s64, 9
    s_add_u32 s65, s65, 20758528
    v_cmp_gt_u32 vcc, 4, v1
    s_and_saveexec_b64 s[4:5], vcc
    buffer_store_dwordx4 v[56:59], v2, s[16:19], s65 offen sc0 sc1
    s_lshl_b32 s65, s53, 9
    v_add_u32 v2, s65, v2
    v_add_u32 v2, 152576, v2
    ds_write_b128 v2, v[56:59]
    s_mov_b64 exec, -1
    s_waitcnt vmcnt(0) lgkmcnt(0)
    s_lshl_b32 s64, s64, 2
    v_mov_b32 v1, 1
    v_mov_b32 v2, 0
    s_mov_b64 exec, 1
    buffer_store_dword v1, v2, s[96:99], s64 offen sc0 sc1
    s_mov_b64 exec, -1
    s_setprio 0
    s_barrier
    ds_read_b128 v[48:51], v4 offset:0
    ds_read_b64_tr_b16 v[40:41], v3 offset:0
    ds_read_b64_tr_b16 v[42:43], v3 offset:160
    s_waitcnt lgkmcnt(0)
    ds_read_b128 v[52:55], v5 offset:0
    ds_read_b64_tr_b16 v[44:45], v3 offset:640
    ds_read_b64_tr_b16 v[46:47], v3 offset:800
    v_mfma_f32_32x32x16_bf16 v[24:39], v[40:43], v[48:51], v[24:39]
    s_waitcnt lgkmcnt(0)
    ds_read_b128 v[48:51], v6 offset:0
    ds_read_b64_tr_b16 v[40:41], v3 offset:1280
    ds_read_b64_tr_b16 v[42:43], v3 offset:1440
    v_mfma_f32_32x32x16_bf16 v[24:39], v[44:47], v[52:55], v[24:39]
    s_waitcnt lgkmcnt(0)
    ds_read_b128 v[52:55], v7 offset:0
    ds_read_b64_tr_b16 v[44:45], v3 offset:1920
    ds_read_b64_tr_b16 v[46:47], v3 offset:2080
    v_mfma_f32_32x32x16_bf16 v[24:39], v[40:43], v[48:51], v[24:39]
    s_waitcnt lgkmcnt(0)
    s_barrier
    ds_read_b128 v[48:51], v4 offset:36864
    ds_read_b64_tr_b16 v[40:41], v3 offset:2560
    ds_read_b64_tr_b16 v[42:43], v3 offset:2720
    v_mfma_f32_32x32x16_bf16 v[24:39], v[44:47], v[52:55], v[24:39]
    s_waitcnt lgkmcnt(0)
    ds_read_b128 v[52:55], v5 offset:36864
    ds_read_b64_tr_b16 v[44:45], v3 offset:3200
    ds_read_b64_tr_b16 v[46:47], v3 offset:3360
    v_mfma_f32_32x32x16_bf16 v[24:39], v[40:43], v[48:51], v[24:39]
    s_waitcnt lgkmcnt(0)
    ds_read_b128 v[48:51], v6 offset:36864
    ds_read_b64_tr_b16 v[40:41], v3 offset:3840
    ds_read_b64_tr_b16 v[42:43], v3 offset:4000
    v_mfma_f32_32x32x16_bf16 v[24:39], v[44:47], v[52:55], v[24:39]
    s_waitcnt lgkmcnt(0)
    ds_read_b128 v[52:55], v7 offset:36864
    ds_read_b64_tr_b16 v[44:45], v3 offset:4480
    ds_read_b64_tr_b16 v[46:47], v3 offset:4640
    v_mfma_f32_32x32x16_bf16 v[24:39], v[40:43], v[48:51], v[24:39]
    s_waitcnt lgkmcnt(0)
    s_barrier
    ds_read_b128 v[48:51], v8 offset:0
    ds_read_b64_tr_b16 v[40:41], v3 offset:5120
    ds_read_b64_tr_b16 v[42:43], v3 offset:5280
    v_mfma_f32_32x32x16_bf16 v[24:39], v[44:47], v[52:55], v[24:39]
    s_waitcnt lgkmcnt(0)
    ds_read_b128 v[52:55], v9 offset:0
    ds_read_b64_tr_b16 v[44:45], v3 offset:5760
    ds_read_b64_tr_b16 v[46:47], v3 offset:5920
    v_mfma_f32_32x32x16_bf16 v[24:39], v[40:43], v[48:51], v[24:39]
    s_waitcnt lgkmcnt(0)
    ds_read_b128 v[48:51], v10 offset:0
    ds_read_b64_tr_b16 v[40:41], v3 offset:6400
    ds_read_b64_tr_b16 v[42:43], v3 offset:6560
    v_mfma_f32_32x32x16_bf16 v[24:39], v[44:47], v[52:55], v[24:39]
    s_waitcnt lgkmcnt(0)
    ds_read_b128 v[52:55], v11 offset:0
    ds_read_b64_tr_b16 v[44:45], v3 offset:7040
    ds_read_b64_tr_b16 v[46:47], v3 offset:7200
    v_mfma_f32_32x32x16_bf16 v[24:39], v[40:43], v[48:51], v[24:39]
    s_waitcnt lgkmcnt(0)
    s_barrier
    ds_read_b128 v[48:51], v8 offset:36864
    ds_read_b64_tr_b16 v[40:41], v3 offset:7680
    ds_read_b64_tr_b16 v[42:43], v3 offset:7840
    v_mfma_f32_32x32x16_bf16 v[24:39], v[44:47], v[52:55], v[24:39]
    s_waitcnt lgkmcnt(0)
    ds_read_b128 v[52:55], v9 offset:36864
    ds_read_b64_tr_b16 v[44:45], v3 offset:8320
    ds_read_b64_tr_b16 v[46:47], v3 offset:8480
    v_mfma_f32_32x32x16_bf16 v[24:39], v[40:43], v[48:51], v[24:39]
    s_waitcnt lgkmcnt(0)
    ds_read_b128 v[48:51], v10 offset:36864
    ds_read_b64_tr_b16 v[40:41], v3 offset:8960
    ds_read_b64_tr_b16 v[42:43], v3 offset:9120
    v_mfma_f32_32x32x16_bf16 v[24:39], v[44:47], v[52:55], v[24:39]
    s_waitcnt lgkmcnt(0)
    ds_read_b128 v[52:55], v11 offset:36864
    ds_read_b64_tr_b16 v[44:45], v3 offset:9600
    ds_read_b64_tr_b16 v[46:47], v3 offset:9760
    v_mfma_f32_32x32x16_bf16 v[24:39], v[40:43], v[48:51], v[24:39]
    s_waitcnt lgkmcnt(0)
    s_barrier
    ds_read_b128 v[48:51], v4 offset:0
    ds_read_b64_tr_b16 v[40:41], v3 offset:10240
    ds_read_b64_tr_b16 v[42:43], v3 offset:10400
    v_mfma_f32_32x32x16_bf16 v[24:39], v[44:47], v[52:55], v[24:39]
    s_waitcnt lgkmcnt(0)
    ds_read_b128 v[52:55], v5 offset:0
    ds_read_b64_tr_b16 v[44:45], v3 offset:10880
    ds_read_b64_tr_b16 v[46:47], v3 offset:11040
    v_mfma_f32_32x32x16_bf16 v[24:39], v[40:43], v[48:51], v[24:39]
    s_waitcnt lgkmcnt(0)
    ds_read_b128 v[48:51], v6 offset:0
    ds_read_b64_tr_b16 v[40:41], v3 offset:11520
    ds_read_b64_tr_b16 v[42:43], v3 offset:11680
    v_mfma_f32_32x32x16_bf16 v[24:39], v[44:47], v[52:55], v[24:39]
    s_waitcnt lgkmcnt(0)
    ds_read_b128 v[52:55], v7 offset:0
    ds_read_b64_tr_b16 v[44:45], v3 offset:12160
    ds_read_b64_tr_b16 v[46:47], v3 offset:12320
    v_mfma_f32_32x32x16_bf16 v[24:39], v[40:43], v[48:51], v[24:39]
    s_waitcnt lgkmcnt(0)
    s_barrier
    ds_read_b128 v[48:51], v4 offset:36864
    ds_read_b64_tr_b16 v[40:41], v3 offset:36864
    ds_read_b64_tr_b16 v[42:43], v3 offset:37024
    v_mfma_f32_32x32x16_bf16 v[24:39], v[44:47], v[52:55], v[24:39]
    s_waitcnt lgkmcnt(0)
    ds_read_b128 v[52:55], v5 offset:36864
    ds_read_b64_tr_b16 v[44:45], v3 offset:37504
    ds_read_b64_tr_b16 v[46:47], v3 offset:37664
    v_mfma_f32_32x32x16_bf16 v[24:39], v[40:43], v[48:51], v[24:39]
    s_waitcnt lgkmcnt(0)
    ds_read_b128 v[48:51], v6 offset:36864
    ds_read_b64_tr_b16 v[40:41], v3 offset:38144
    ds_read_b64_tr_b16 v[42:43], v3 offset:38304
    v_mfma_f32_32x32x16_bf16 v[24:39], v[44:47], v[52:55], v[24:39]
    s_waitcnt lgkmcnt(0)
    ds_read_b128 v[52:55], v7 offset:36864
    ds_read_b64_tr_b16 v[44:45], v3 offset:38784
    ds_read_b64_tr_b16 v[46:47], v3 offset:38944
    v_mfma_f32_32x32x16_bf16 v[24:39], v[40:43], v[48:51], v[24:39]
    s_waitcnt lgkmcnt(0)
    s_barrier
    ds_read_b128 v[48:51], v8 offset:0
    ds_read_b64_tr_b16 v[40:41], v3 offset:39424
    ds_read_b64_tr_b16 v[42:43], v3 offset:39584
    v_mfma_f32_32x32x16_bf16 v[24:39], v[44:47], v[52:55], v[24:39]
    s_waitcnt lgkmcnt(0)
    ds_read_b128 v[52:55], v9 offset:0
    ds_read_b64_tr_b16 v[44:45], v3 offset:40064
    ds_read_b64_tr_b16 v[46:47], v3 offset:40224
    v_mfma_f32_32x32x16_bf16 v[24:39], v[40:43], v[48:51], v[24:39]
    s_waitcnt lgkmcnt(0)
    ds_read_b128 v[48:51], v10 offset:0
    ds_read_b64_tr_b16 v[40:41], v3 offset:40704
    ds_read_b64_tr_b16 v[42:43], v3 offset:40864
    v_mfma_f32_32x32x16_bf16 v[24:39], v[44:47], v[52:55], v[24:39]
    s_waitcnt lgkmcnt(0)
    ds_read_b128 v[52:55], v11 offset:0
    ds_read_b64_tr_b16 v[44:45], v3 offset:41344
    ds_read_b64_tr_b16 v[46:47], v3 offset:41504
    v_mfma_f32_32x32x16_bf16 v[24:39], v[40:43], v[48:51], v[24:39]
    s_waitcnt lgkmcnt(0)
    s_barrier
    ds_read_b128 v[48:51], v8 offset:36864
    ds_read_b64_tr_b16 v[40:41], v3 offset:41984
    ds_read_b64_tr_b16 v[42:43], v3 offset:42144
    v_mfma_f32_32x32x16_bf16 v[24:39], v[44:47], v[52:55], v[24:39]
    s_waitcnt lgkmcnt(0)
    ds_read_b128 v[52:55], v9 offset:36864
    ds_read_b64_tr_b16 v[44:45], v3 offset:42624
    ds_read_b64_tr_b16 v[46:47], v3 offset:42784
    v_mfma_f32_32x32x16_bf16 v[24:39], v[40:43], v[48:51], v[24:39]
    s_waitcnt lgkmcnt(0)
    ds_read_b128 v[48:51], v10 offset:36864
    ds_read_b64_tr_b16 v[40:41], v3 offset:43264
    ds_read_b64_tr_b16 v[42:43], v3 offset:43424
    v_mfma_f32_32x32x16_bf16 v[24:39], v[44:47], v[52:55], v[24:39]
    s_waitcnt lgkmcnt(0)
    ds_read_b128 v[52:55], v11 offset:36864
    ds_read_b64_tr_b16 v[44:45], v3 offset:43904
    ds_read_b64_tr_b16 v[46:47], v3 offset:44064
    v_mfma_f32_32x32x16_bf16 v[24:39], v[40:43], v[48:51], v[24:39]
    s_waitcnt lgkmcnt(0)
    s_barrier
    ds_read_b128 v[48:51], v4 offset:0
    ds_read_b64_tr_b16 v[40:41], v3 offset:44544
    ds_read_b64_tr_b16 v[42:43], v3 offset:44704
    v_mfma_f32_32x32x16_bf16 v[24:39], v[44:47], v[52:55], v[24:39]
    s_waitcnt lgkmcnt(0)
    ds_read_b128 v[52:55], v5 offset:0
    ds_read_b64_tr_b16 v[44:45], v3 offset:45184
    ds_read_b64_tr_b16 v[46:47], v3 offset:45344
    v_mfma_f32_32x32x16_bf16 v[24:39], v[40:43], v[48:51], v[24:39]
    s_waitcnt lgkmcnt(0)
    ds_read_b128 v[48:51], v6 offset:0
    ds_read_b64_tr_b16 v[40:41], v3 offset:45824
    ds_read_b64_tr_b16 v[42:43], v3 offset:45984
    v_mfma_f32_32x32x16_bf16 v[24:39], v[44:47], v[52:55], v[24:39]
    s_waitcnt lgkmcnt(0)
    ds_read_b128 v[52:55], v7 offset:0
    ds_read_b64_tr_b16 v[44:45], v3 offset:46464
    ds_read_b64_tr_b16 v[46:47], v3 offset:46624
    v_mfma_f32_32x32x16_bf16 v[24:39], v[40:43], v[48:51], v[24:39]
    s_waitcnt lgkmcnt(0)
    s_barrier
    ds_read_b128 v[48:51], v4 offset:36864
    ds_read_b64_tr_b16 v[40:41], v3 offset:47104
    ds_read_b64_tr_b16 v[42:43], v3 offset:47264
    v_mfma_f32_32x32x16_bf16 v[24:39], v[44:47], v[52:55], v[24:39]
    s_waitcnt lgkmcnt(0)
    ds_read_b128 v[52:55], v5 offset:36864
    ds_read_b64_tr_b16 v[44:45], v3 offset:47744
    ds_read_b64_tr_b16 v[46:47], v3 offset:47904
    v_mfma_f32_32x32x16_bf16 v[24:39], v[40:43], v[48:51], v[24:39]
    s_waitcnt lgkmcnt(0)
    ds_read_b128 v[48:51], v6 offset:36864
    ds_read_b64_tr_b16 v[40:41], v3 offset:48384
    ds_read_b64_tr_b16 v[42:43], v3 offset:48544
    v_mfma_f32_32x32x16_bf16 v[24:39], v[44:47], v[52:55], v[24:39]
    s_waitcnt lgkmcnt(0)
    ds_read_b128 v[52:55], v7 offset:36864
    ds_read_b64_tr_b16 v[44:45], v3 offset:49024
    ds_read_b64_tr_b16 v[46:47], v3 offset:49184
    v_mfma_f32_32x32x16_bf16 v[24:39], v[40:43], v[48:51], v[24:39]
    s_waitcnt lgkmcnt(0)
    v_mfma_f32_32x32x16_bf16 v[24:39], v[44:47], v[52:55], v[24:39]
    v_and_b32 v1, 31, v0
    s_lshl_b32 s64, s53, 5
    v_add_u32 v1, s64, v1
    v_lshlrev_b32 v1, 4, v1
    v_add_u32 v1, 152576, v1
    ds_read_b128 v[56:59], v1
    ds_read_b64_tr_b16 v[64:65], v3 offset:0
    ds_read_b64_tr_b16 v[66:67], v3 offset:160
    ds_read_b64_tr_b16 v[68:69], v3 offset:640
    ds_read_b64_tr_b16 v[70:71], v3 offset:800
    ds_read_b64_tr_b16 v[72:73], v3 offset:1280
    ds_read_b64_tr_b16 v[74:75], v3 offset:1440
    ds_read_b64_tr_b16 v[76:77], v3 offset:1920
    ds_read_b64_tr_b16 v[78:79], v3 offset:2080
    s_waitcnt lgkmcnt(0)
    v_dot2_f32_bf16 v19, v64, v13, v19
    v_dot2_f32_bf16 v20, v68, v13, v20
    v_dot2_f32_bf16 v21, v72, v13, v21
    v_dot2_f32_bf16 v22, v76, v13, v22
    v_dot2_f32_bf16 v19, v65, v13, v19
    v_dot2_f32_bf16 v20, v69, v13, v20
    v_dot2_f32_bf16 v21, v73, v13, v21
    v_dot2_f32_bf16 v22, v77, v13, v22
    v_dot2_f32_bf16 v19, v66, v13, v19
    v_dot2_f32_bf16 v20, v70, v13, v20
    v_dot2_f32_bf16 v21, v74, v13, v21
    v_dot2_f32_bf16 v22, v78, v13, v22
    v_dot2_f32_bf16 v19, v67, v13, v19
    v_dot2_f32_bf16 v20, v71, v13, v20
    v_dot2_f32_bf16 v21, v75, v13, v21
    v_dot2_f32_bf16 v22, v79, v13, v22
    ds_read_b64_tr_b16 v[64:65], v3 offset:2560
    ds_read_b64_tr_b16 v[66:67], v3 offset:2720
    ds_read_b64_tr_b16 v[68:69], v3 offset:3200
    ds_read_b64_tr_b16 v[70:71], v3 offset:3360
    ds_read_b64_tr_b16 v[72:73], v3 offset:3840
    ds_read_b64_tr_b16 v[74:75], v3 offset:4000
    ds_read_b64_tr_b16 v[76:77], v3 offset:4480
    ds_read_b64_tr_b16 v[78:79], v3 offset:4640
    s_waitcnt lgkmcnt(0)
    v_dot2_f32_bf16 v19, v64, v13, v19
    v_dot2_f32_bf16 v20, v68, v13, v20
    v_dot2_f32_bf16 v21, v72, v13, v21
    v_dot2_f32_bf16 v22, v76, v13, v22
    v_dot2_f32_bf16 v19, v65, v13, v19
    v_dot2_f32_bf16 v20, v69, v13, v20
    v_dot2_f32_bf16 v21, v73, v13, v21
    v_dot2_f32_bf16 v22, v77, v13, v22
    v_dot2_f32_bf16 v19, v66, v13, v19
    v_dot2_f32_bf16 v20, v70, v13, v20
    v_dot2_f32_bf16 v21, v74, v13, v21
    v_dot2_f32_bf16 v22, v78, v13, v22
    v_dot2_f32_bf16 v19, v67, v13, v19
    v_dot2_f32_bf16 v20, v71, v13, v20
    v_dot2_f32_bf16 v21, v75, v13, v21
    v_dot2_f32_bf16 v22, v79, v13, v22
    ds_read_b64_tr_b16 v[64:65], v3 offset:5120
    ds_read_b64_tr_b16 v[66:67], v3 offset:5280
    ds_read_b64_tr_b16 v[68:69], v3 offset:5760
    ds_read_b64_tr_b16 v[70:71], v3 offset:5920
    ds_read_b64_tr_b16 v[72:73], v3 offset:6400
    ds_read_b64_tr_b16 v[74:75], v3 offset:6560
    ds_read_b64_tr_b16 v[76:77], v3 offset:7040
    ds_read_b64_tr_b16 v[78:79], v3 offset:7200
    s_waitcnt lgkmcnt(0)
    v_dot2_f32_bf16 v19, v64, v13, v19
    v_dot2_f32_bf16 v20, v68, v13, v20
    v_dot2_f32_bf16 v21, v72, v13, v21
    v_dot2_f32_bf16 v22, v76, v13, v22
    v_dot2_f32_bf16 v19, v65, v13, v19
    v_dot2_f32_bf16 v20, v69, v13, v20
    v_dot2_f32_bf16 v21, v73, v13, v21
    v_dot2_f32_bf16 v22, v77, v13, v22
    v_dot2_f32_bf16 v19, v66, v13, v19
    v_dot2_f32_bf16 v20, v70, v13, v20
    v_dot2_f32_bf16 v21, v74, v13, v21
    v_dot2_f32_bf16 v22, v78, v13, v22
    v_dot2_f32_bf16 v19, v67, v13, v19
    v_dot2_f32_bf16 v20, v71, v13, v20
    v_dot2_f32_bf16 v21, v75, v13, v21
    v_dot2_f32_bf16 v22, v79, v13, v22
    ds_read_b64_tr_b16 v[64:65], v3 offset:7680
    ds_read_b64_tr_b16 v[66:67], v3 offset:7840
    ds_read_b64_tr_b16 v[68:69], v3 offset:8320
    ds_read_b64_tr_b16 v[70:71], v3 offset:8480
    ds_read_b64_tr_b16 v[72:73], v3 offset:8960
    ds_read_b64_tr_b16 v[74:75], v3 offset:9120
    ds_read_b64_tr_b16 v[76:77], v3 offset:9600
    ds_read_b64_tr_b16 v[78:79], v3 offset:9760
    s_waitcnt lgkmcnt(0)
    v_dot2_f32_bf16 v19, v64, v13, v19
    v_dot2_f32_bf16 v20, v68, v13, v20
    v_dot2_f32_bf16 v21, v72, v13, v21
    v_dot2_f32_bf16 v22, v76, v13, v22
    v_dot2_f32_bf16 v19, v65, v13, v19
    v_dot2_f32_bf16 v20, v69, v13, v20
    v_dot2_f32_bf16 v21, v73, v13, v21
    v_dot2_f32_bf16 v22, v77, v13, v22
    v_dot2_f32_bf16 v19, v66, v13, v19
    v_dot2_f32_bf16 v20, v70, v13, v20
    v_dot2_f32_bf16 v21, v74, v13, v21
    v_dot2_f32_bf16 v22, v78, v13, v22
    v_dot2_f32_bf16 v19, v67, v13, v19
    v_dot2_f32_bf16 v20, v71, v13, v20
    v_dot2_f32_bf16 v21, v75, v13, v21
    v_dot2_f32_bf16 v22, v79, v13, v22
    ds_read_b64_tr_b16 v[64:65], v3 offset:10240
    ds_read_b64_tr_b16 v[66:67], v3 offset:10400
    ds_read_b64_tr_b16 v[68:69], v3 offset:10880
    ds_read_b64_tr_b16 v[70:71], v3 offset:11040
    ds_read_b64_tr_b16 v[72:73], v3 offset:11520
    ds_read_b64_tr_b16 v[74:75], v3 offset:11680
    ds_read_b64_tr_b16 v[76:77], v3 offset:12160
    ds_read_b64_tr_b16 v[78:79], v3 offset:12320
    s_waitcnt lgkmcnt(0)
    v_dot2_f32_bf16 v19, v64, v13, v19
    v_dot2_f32_bf16 v20, v68, v13, v20
    v_dot2_f32_bf16 v21, v72, v13, v21
    v_dot2_f32_bf16 v22, v76, v13, v22
    v_dot2_f32_bf16 v19, v65, v13, v19
    v_dot2_f32_bf16 v20, v69, v13, v20
    v_dot2_f32_bf16 v21, v73, v13, v21
    v_dot2_f32_bf16 v22, v77, v13, v22
    v_dot2_f32_bf16 v19, v66, v13, v19
    v_dot2_f32_bf16 v20, v70, v13, v20
    v_dot2_f32_bf16 v21, v74, v13, v21
    v_dot2_f32_bf16 v22, v78, v13, v22
    v_dot2_f32_bf16 v19, v67, v13, v19
    v_dot2_f32_bf16 v20, v71, v13, v20
    v_dot2_f32_bf16 v21, v75, v13, v21
    v_dot2_f32_bf16 v22, v79, v13, v22
    ds_read_b64_tr_b16 v[64:65], v3 offset:36864
    ds_read_b64_tr_b16 v[66:67], v3 offset:37024
    ds_read_b64_tr_b16 v[68:69], v3 offset:37504
    ds_read_b64_tr_b16 v[70:71], v3 offset:37664
    ds_read_b64_tr_b16 v[72:73], v3 offset:38144
    ds_read_b64_tr_b16 v[74:75], v3 offset:38304
    ds_read_b64_tr_b16 v[76:77], v3 offset:38784
    ds_read_b64_tr_b16 v[78:79], v3 offset:38944
    s_waitcnt lgkmcnt(0)
    v_dot2_f32_bf16 v19, v64, v13, v19
    v_dot2_f32_bf16 v20, v68, v13, v20
    v_dot2_f32_bf16 v21, v72, v13, v21
    v_dot2_f32_bf16 v22, v76, v13, v22
    v_dot2_f32_bf16 v19, v65, v13, v19
    v_dot2_f32_bf16 v20, v69, v13, v20
    v_dot2_f32_bf16 v21, v73, v13, v21
    v_dot2_f32_bf16 v22, v77, v13, v22
    v_dot2_f32_bf16 v19, v66, v13, v19
    v_dot2_f32_bf16 v20, v70, v13, v20
    v_dot2_f32_bf16 v21, v74, v13, v21
    v_dot2_f32_bf16 v22, v78, v13, v22
    v_dot2_f32_bf16 v19, v67, v13, v19
    v_dot2_f32_bf16 v20, v71, v13, v20
    v_dot2_f32_bf16 v21, v75, v13, v21
    v_dot2_f32_bf16 v22, v79, v13, v22
    ds_read_b64_tr_b16 v[64:65], v3 offset:39424
    ds_read_b64_tr_b16 v[66:67], v3 offset:39584
    ds_read_b64_tr_b16 v[68:69], v3 offset:40064
    ds_read_b64_tr_b16 v[70:71], v3 offset:40224
    ds_read_b64_tr_b16 v[72:73], v3 offset:40704
    ds_read_b64_tr_b16 v[74:75], v3 offset:40864
    ds_read_b64_tr_b16 v[76:77], v3 offset:41344
    ds_read_b64_tr_b16 v[78:79], v3 offset:41504
    s_waitcnt lgkmcnt(0)
    v_dot2_f32_bf16 v19, v64, v13, v19
    v_dot2_f32_bf16 v20, v68, v13, v20
    v_dot2_f32_bf16 v21, v72, v13, v21
    v_dot2_f32_bf16 v22, v76, v13, v22
    v_dot2_f32_bf16 v19, v65, v13, v19
    v_dot2_f32_bf16 v20, v69, v13, v20
    v_dot2_f32_bf16 v21, v73, v13, v21
    v_dot2_f32_bf16 v22, v77, v13, v22
    v_dot2_f32_bf16 v19, v66, v13, v19
    v_dot2_f32_bf16 v20, v70, v13, v20
    v_dot2_f32_bf16 v21, v74, v13, v21
    v_dot2_f32_bf16 v22, v78, v13, v22
    v_dot2_f32_bf16 v19, v67, v13, v19
    v_dot2_f32_bf16 v20, v71, v13, v20
    v_dot2_f32_bf16 v21, v75, v13, v21
    v_dot2_f32_bf16 v22, v79, v13, v22
    ds_read_b64_tr_b16 v[64:65], v3 offset:41984
    ds_read_b64_tr_b16 v[66:67], v3 offset:42144
    ds_read_b64_tr_b16 v[68:69], v3 offset:42624
    ds_read_b64_tr_b16 v[70:71], v3 offset:42784
    ds_read_b64_tr_b16 v[72:73], v3 offset:43264
    ds_read_b64_tr_b16 v[74:75], v3 offset:43424
    ds_read_b64_tr_b16 v[76:77], v3 offset:43904
    ds_read_b64_tr_b16 v[78:79], v3 offset:44064
    s_waitcnt lgkmcnt(0)
    v_dot2_f32_bf16 v19, v64, v13, v19
    v_dot2_f32_bf16 v20, v68, v13, v20
    v_dot2_f32_bf16 v21, v72, v13, v21
    v_dot2_f32_bf16 v22, v76, v13, v22
    v_dot2_f32_bf16 v19, v65, v13, v19
    v_dot2_f32_bf16 v20, v69, v13, v20
    v_dot2_f32_bf16 v21, v73, v13, v21
    v_dot2_f32_bf16 v22, v77, v13, v22
    v_dot2_f32_bf16 v19, v66, v13, v19
    v_dot2_f32_bf16 v20, v70, v13, v20
    v_dot2_f32_bf16 v21, v74, v13, v21
    v_dot2_f32_bf16 v22, v78, v13, v22
    v_dot2_f32_bf16 v19, v67, v13, v19
    v_dot2_f32_bf16 v20, v71, v13, v20
    v_dot2_f32_bf16 v21, v75, v13, v21
    v_dot2_f32_bf16 v22, v79, v13, v22
    ds_read_b64_tr_b16 v[64:65], v3 offset:44544
    ds_read_b64_tr_b16 v[66:67], v3 offset:44704
    ds_read_b64_tr_b16 v[68:69], v3 offset:45184
    ds_read_b64_tr_b16 v[70:71], v3 offset:45344
    ds_read_b64_tr_b16 v[72:73], v3 offset:45824
    ds_read_b64_tr_b16 v[74:75], v3 offset:45984
    ds_read_b64_tr_b16 v[76:77], v3 offset:46464
    ds_read_b64_tr_b16 v[78:79], v3 offset:46624
    s_waitcnt lgkmcnt(0)
    v_dot2_f32_bf16 v19, v64, v13, v19
    v_dot2_f32_bf16 v20, v68, v13, v20
    v_dot2_f32_bf16 v21, v72, v13, v21
    v_dot2_f32_bf16 v22, v76, v13, v22
    v_dot2_f32_bf16 v19, v65, v13, v19
    v_dot2_f32_bf16 v20, v69, v13, v20
    v_dot2_f32_bf16 v21, v73, v13, v21
    v_dot2_f32_bf16 v22, v77, v13, v22
    v_dot2_f32_bf16 v19, v66, v13, v19
    v_dot2_f32_bf16 v20, v70, v13, v20
    v_dot2_f32_bf16 v21, v74, v13, v21
    v_dot2_f32_bf16 v22, v78, v13, v22
    v_dot2_f32_bf16 v19, v67, v13, v19
    v_dot2_f32_bf16 v20, v71, v13, v20
    v_dot2_f32_bf16 v21, v75, v13, v21
    v_dot2_f32_bf16 v22, v79, v13, v22
    ds_read_b64_tr_b16 v[64:65], v3 offset:47104
    ds_read_b64_tr_b16 v[66:67], v3 offset:47264
    ds_read_b64_tr_b16 v[68:69], v3 offset:47744
    ds_read_b64_tr_b16 v[70:71], v3 offset:47904
    ds_read_b64_tr_b16 v[72:73], v3 offset:48384
    ds_read_b64_tr_b16 v[74:75], v3 offset:48544
    ds_read_b64_tr_b16 v[76:77], v3 offset:49024
    ds_read_b64_tr_b16 v[78:79], v3 offset:49184
    s_waitcnt lgkmcnt(0)
    v_dot2_f32_bf16 v19, v64, v13, v19
    v_dot2_f32_bf16 v20, v68, v13, v20
    v_dot2_f32_bf16 v21, v72, v13, v21
    v_dot2_f32_bf16 v22, v76, v13, v22
    v_dot2_f32_bf16 v19, v65, v13, v19
    v_dot2_f32_bf16 v20, v69, v13, v20
    v_dot2_f32_bf16 v21, v73, v13, v21
    v_dot2_f32_bf16 v22, v77, v13, v22
    v_dot2_f32_bf16 v19, v66, v13, v19
    v_dot2_f32_bf16 v20, v70, v13, v20
    v_dot2_f32_bf16 v21, v74, v13, v21
    v_dot2_f32_bf16 v22, v78, v13, v22
    v_dot2_f32_bf16 v19, v67, v13, v19
    v_dot2_f32_bf16 v20, v71, v13, v20
    v_dot2_f32_bf16 v21, v75, v13, v21
    v_dot2_f32_bf16 v22, v79, v13, v22
    s_nop 3
    v_add_f32 v19, v19, v20
    v_add_f32 v21, v21, v22
    v_add_f32 v18, v19, v21
    v_mov_b32 v1, v18
    s_nop 1
    v_permlane32_swap_b32 v18, v1
    s_nop 1
    v_add_f32 v18, v18, v1
    v_cmp_gt_u32 vcc, 32, v0
    s_nop 1
    v_cndmask_b32 v18, 0, v18, vcc
    v_mov_b32 v1, 0
    v_sub_f32 v80, 0, v56
    v_cvt_pk_bf16_f32 v83, v80, v80
    v_and_b32 v81, 0xffff0000, v83
    v_sub_f32 v82, v80, v81
    v_cvt_pk_bf16_f32 v48, v81, v82
    v_cvt_pk_bf16_f32 v83, v58, v58
    v_and_b32 v80, 0xffff0000, v83
    v_sub_f32 v82, v58, v80
    v_cvt_pk_bf16_f32 v49, v81, v80
    v_mov_b32 v51, 0
    v_cvt_pk_bf16_f32 v50, v82, v51
    v_cvt_pk_bf16_f32 v40, v18, v18
    v_and_b32 v80, 0xffff0000, v40
    v_sub_f32 v81, v18, v80
    v_cvt_pk_bf16_f32 v41, v81, v1
    v_mov_b32 v43, 0
    v_cvt_pk_bf16_f32 v42, v1, v43
    s_nop 1
    v_mfma_f32_32x32x16_bf16 v[24:39], v[40:43], v[48:51], v[24:39]
    s_nop 15
    v_mul_f32 v24, v24, v57
    v_mul_f32 v25, v25, v57
    v_mul_f32 v26, v26, v57
    v_mul_f32 v27, v27, v57
    v_mul_f32 v28, v28, v57
    v_mul_f32 v29, v29, v57
    v_mul_f32 v30, v30, v57
    v_mul_f32 v31, v31, v57
    v_mul_f32 v32, v32, v57
    v_mul_f32 v33, v33, v57
    v_mul_f32 v34, v34, v57
    v_mul_f32 v35, v35, v57
    v_cvt_pk_bf16_f32 v24, v24, v25
    v_cvt_pk_bf16_f32 v25, v26, v27
    v_cvt_pk_bf16_f32 v26, v28, v29
    v_cvt_pk_bf16_f32 v27, v30, v31
    v_cvt_pk_bf16_f32 v28, v32, v33
    v_cvt_pk_bf16_f32 v29, v34, v35
    buffer_store_dwordx4 v[24:27], v12, s[16:19], s62 offen sc0 sc1
    v_lshlrev_b32 v1, 3, v0
    v_cmp_gt_u32 vcc, 32, v0
    s_and_saveexec_b64 s[4:5], vcc
    buffer_store_dwordx2 v[28:29], v1, s[16:19], s62 offen offset:1024 sc0 sc1
    s_endpgm
K1_KV1:
    s_waitcnt lgkmcnt(0)
    s_mov_b32 s42, s78
    s_mov_b32 s43, s79
    s_mov_b32 s6, s76
    s_mov_b32 s7, s77
    s_mov_b32 s8, s24
    s_and_b32 s9, s25, 0xffff
    s_mov_b32 s10, 2621440
    s_mov_b32 s11, 0x20000
    s_mov_b32 s16, s42
    s_and_b32 s17, s43, 0xffff
    s_mov_b32 s18, 21872640
    s_mov_b32 s19, 0x20000
    s_mov_b32 s96, s6
    s_and_b32 s97, s7, 0xffff
    s_mov_b32 s98, 256
    s_mov_b32 s99, 0x20000
    s_lshl_b32 s3, s55, 2
    s_add_u32 s3, s3, s53
    s_mul_i32 s62, s3, 2560
    s_add_u32 s62, s62, 9699328
    v_lshlrev_b32 v12, 4, v0
    v_lshrrev_b32 v3, 5, v0
    v_mul_u32_u24 v3, 8, v3
    v_bfe_u32 v1, v0, 2, 2
    v_add_u32 v3, v3, v1
    v_mul_u32_u24 v3, 40, v3
    v_bfe_u32 v1, v0, 4, 1
    v_lshl_add_u32 v3, v1, 5, v3
    v_and_b32 v1, 3, v0
    v_lshl_add_u32 v3, v1, 3, v3
    v_add_u32 v3, 73728, v3
    v_and_b32 v1, 31, v0
    v_bfe_u32 v2, v0, 1, 3
    v_lshrrev_b32 v4, 5, v0
    v_xor_b32 v2, v2, v4
    v_lshlrev_b32 v2, 4, v2
    s_lshl_b32 s64, s53, 5
    v_add_u32 v1, s64, v1
    v_lshlrev_b32 v1, 7, v1
    v_add_u32 v1, v1, v2
    v_add_u32 v4, 20480, v1
    v_xor_b32 v5, 32, v4
    v_xor_b32 v6, 64, v4
    v_xor_b32 v7, 96, v4
    v_add_u32 v8, 73728, v4
    v_add_u32 v9, 73728, v5
    v_add_u32 v10, 73728, v6
    v_add_u32 v11, 73728, v7
    v_mov_b32 v13, 0x3f803f80
    v_mov_b32 v14, 0
    v_mov_b32 v15, 0
    v_mov_b32 v16, 0
    v_mov_b32 v17, 0
    v_mov_b32 v18, 0
    v_mov_b32 v19, 0
    v_mov_b32 v20, 0
    v_mov_b32 v21, 0
    v_mov_b32 v22, 0
    v_mov_b32 v24, 0
    v_mov_b32 v25, 0
    v_mov_b32 v26, 0
    v_mov_b32 v27, 0
    v_mov_b32 v28, 0
    v_mov_b32 v29, 0
    v_mov_b32 v30, 0
    v_mov_b32 v31, 0
    v_mov_b32 v32, 0
    v_mov_b32 v33, 0
    v_mov_b32 v34, 0
    v_mov_b32 v35, 0
    v_mov_b32 v36, 0
    v_mov_b32 v37, 0
    v_mov_b32 v38, 0
    v_mov_b32 v39, 0
    s_barrier
    ds_read_b128 v[48:51], v4 offset:0
    ds_read_b64_tr_b16 v[40:41], v3 offset:0
    ds_read_b64_tr_b16 v[42:43], v3 offset:160
    s_waitcnt lgkmcnt(0)
    ds_read_b128 v[52:55], v5 offset:0
    ds_read_b64_tr_b16 v[44:45], v3 offset:640
    ds_read_b64_tr_b16 v[46:47], v3 offset:800
    v_mfma_f32_32x32x16_bf16 v[24:39], v[48:51], v[40:43], v[24:39]
    s_waitcnt lgkmcnt(0)
    ds_read_b128 v[48:51], v6 offset:0
    ds_read_b64_tr_b16 v[40:41], v3 offset:1280
    ds_read_b64_tr_b16 v[42:43], v3 offset:1440
    v_mfma_f32_32x32x16_bf16 v[24:39], v[52:55], v[44:47], v[24:39]
    s_waitcnt lgkmcnt(0)
    ds_read_b128 v[52:55], v7 offset:0
    ds_read_b64_tr_b16 v[44:45], v3 offset:1920
    ds_read_b64_tr_b16 v[46:47], v3 offset:2080
    v_mfma_f32_32x32x16_bf16 v[24:39], v[48:51], v[40:43], v[24:39]
    s_waitcnt lgkmcnt(0)
    s_barrier
    ds_read_b128 v[48:51], v4 offset:36864
    ds_read_b64_tr_b16 v[40:41], v3 offset:2560
    ds_read_b64_tr_b16 v[42:43], v3 offset:2720
    v_mfma_f32_32x32x16_bf16 v[24:39], v[52:55], v[44:47], v[24:39]
    s_waitcnt lgkmcnt(0)
    ds_read_b128 v[52:55], v5 offset:36864
    ds_read_b64_tr_b16 v[44:45], v3 offset:3200
    ds_read_b64_tr_b16 v[46:47], v3 offset:3360
    v_mfma_f32_32x32x16_bf16 v[24:39], v[48:51], v[40:43], v[24:39]
    s_waitcnt lgkmcnt(0)
    ds_read_b128 v[48:51], v6 offset:36864
    ds_read_b64_tr_b16 v[40:41], v3 offset:3840
    ds_read_b64_tr_b16 v[42:43], v3 offset:4000
    v_mfma_f32_32x32x16_bf16 v[24:39], v[52:55], v[44:47], v[24:39]
    s_waitcnt lgkmcnt(0)
    ds_read_b128 v[52:55], v7 offset:36864
    ds_read_b64_tr_b16 v[44:45], v3 offset:4480
    ds_read_b64_tr_b16 v[46:47], v3 offset:4640
    v_mfma_f32_32x32x16_bf16 v[24:39], v[48:51], v[40:43], v[24:39]
    s_waitcnt lgkmcnt(0)
    s_barrier
    ds_read_b128 v[48:51], v8 offset:0
    ds_read_b64_tr_b16 v[40:41], v3 offset:5120
    ds_read_b64_tr_b16 v[42:43], v3 offset:5280
    v_mfma_f32_32x32x16_bf16 v[24:39], v[52:55], v[44:47], v[24:39]
    s_waitcnt lgkmcnt(0)
    ds_read_b128 v[52:55], v9 offset:0
    ds_read_b64_tr_b16 v[44:45], v3 offset:5760
    ds_read_b64_tr_b16 v[46:47], v3 offset:5920
    v_mfma_f32_32x32x16_bf16 v[24:39], v[48:51], v[40:43], v[24:39]
    s_waitcnt lgkmcnt(0)
    ds_read_b128 v[48:51], v10 offset:0
    ds_read_b64_tr_b16 v[40:41], v3 offset:6400
    ds_read_b64_tr_b16 v[42:43], v3 offset:6560
    v_mfma_f32_32x32x16_bf16 v[24:39], v[52:55], v[44:47], v[24:39]
    s_waitcnt lgkmcnt(0)
    ds_read_b128 v[52:55], v11 offset:0
    ds_read_b64_tr_b16 v[44:45], v3 offset:7040
    ds_read_b64_tr_b16 v[46:47], v3 offset:7200
    v_mfma_f32_32x32x16_bf16 v[24:39], v[48:51], v[40:43], v[24:39]
    s_waitcnt lgkmcnt(0)
    s_barrier
    ds_read_b128 v[48:51], v8 offset:36864
    ds_read_b64_tr_b16 v[40:41], v3 offset:7680
    ds_read_b64_tr_b16 v[42:43], v3 offset:7840
    v_mfma_f32_32x32x16_bf16 v[24:39], v[52:55], v[44:47], v[24:39]
    s_waitcnt lgkmcnt(0)
    ds_read_b128 v[52:55], v9 offset:36864
    ds_read_b64_tr_b16 v[44:45], v3 offset:8320
    ds_read_b64_tr_b16 v[46:47], v3 offset:8480
    v_mfma_f32_32x32x16_bf16 v[24:39], v[48:51], v[40:43], v[24:39]
    s_waitcnt lgkmcnt(0)
    ds_read_b128 v[48:51], v10 offset:36864
    ds_read_b64_tr_b16 v[40:41], v3 offset:8960
    ds_read_b64_tr_b16 v[42:43], v3 offset:9120
    v_mfma_f32_32x32x16_bf16 v[24:39], v[52:55], v[44:47], v[24:39]
    s_waitcnt lgkmcnt(0)
    ds_read_b128 v[52:55], v11 offset:36864
    ds_read_b64_tr_b16 v[44:45], v3 offset:9600
    ds_read_b64_tr_b16 v[46:47], v3 offset:9760
    v_mfma_f32_32x32x16_bf16 v[24:39], v[48:51], v[40:43], v[24:39]
    s_waitcnt lgkmcnt(0)
    s_barrier
    ds_read_b128 v[48:51], v4 offset:0
    ds_read_b64_tr_b16 v[40:41], v3 offset:10240
    ds_read_b64_tr_b16 v[42:43], v3 offset:10400
    v_mfma_f32_32x32x16_bf16 v[24:39], v[52:55], v[44:47], v[24:39]
    s_waitcnt lgkmcnt(0)
    ds_read_b128 v[52:55], v5 offset:0
    ds_read_b64_tr_b16 v[44:45], v3 offset:10880
    ds_read_b64_tr_b16 v[46:47], v3 offset:11040
    v_mfma_f32_32x32x16_bf16 v[24:39], v[48:51], v[40:43], v[24:39]
    s_waitcnt lgkmcnt(0)
    ds_read_b128 v[48:51], v6 offset:0
    ds_read_b64_tr_b16 v[40:41], v3 offset:11520
    ds_read_b64_tr_b16 v[42:43], v3 offset:11680
    v_mfma_f32_32x32x16_bf16 v[24:39], v[52:55], v[44:47], v[24:39]
    s_waitcnt lgkmcnt(0)
    ds_read_b128 v[52:55], v7 offset:0
    ds_read_b64_tr_b16 v[44:45], v3 offset:12160
    ds_read_b64_tr_b16 v[46:47], v3 offset:12320
    v_mfma_f32_32x32x16_bf16 v[24:39], v[48:51], v[40:43], v[24:39]
    s_waitcnt lgkmcnt(0)
    s_barrier
    ds_read_b128 v[48:51], v4 offset:36864
    ds_read_b64_tr_b16 v[40:41], v3 offset:36864
    ds_read_b64_tr_b16 v[42:43], v3 offset:37024
    v_mfma_f32_32x32x16_bf16 v[24:39], v[52:55], v[44:47], v[24:39]
    s_waitcnt lgkmcnt(0)
    ds_read_b128 v[52:55], v5 offset:36864
    ds_read_b64_tr_b16 v[44:45], v3 offset:37504
    ds_read_b64_tr_b16 v[46:47], v3 offset:37664
    v_mfma_f32_32x32x16_bf16 v[24:39], v[48:51], v[40:43], v[24:39]
    s_waitcnt lgkmcnt(0)
    ds_read_b128 v[48:51], v6 offset:36864
    ds_read_b64_tr_b16 v[40:41], v3 offset:38144
    ds_read_b64_tr_b16 v[42:43], v3 offset:38304
    v_mfma_f32_32x32x16_bf16 v[24:39], v[52:55], v[44:47], v[24:39]
    s_waitcnt lgkmcnt(0)
    ds_read_b128 v[52:55], v7 offset:36864
    ds_read_b64_tr_b16 v[44:45], v3 offset:38784
    ds_read_b64_tr_b16 v[46:47], v3 offset:38944
    v_mfma_f32_32x32x16_bf16 v[24:39], v[48:51], v[40:43], v[24:39]
    s_waitcnt lgkmcnt(0)
    s_barrier
    ds_read_b128 v[48:51], v8 offset:0
    ds_read_b64_tr_b16 v[40:41], v3 offset:39424
    ds_read_b64_tr_b16 v[42:43], v3 offset:39584
    v_mfma_f32_32x32x16_bf16 v[24:39], v[52:55], v[44:47], v[24:39]
    s_waitcnt lgkmcnt(0)
    ds_read_b128 v[52:55], v9 offset:0
    ds_read_b64_tr_b16 v[44:45], v3 offset:40064
    ds_read_b64_tr_b16 v[46:47], v3 offset:40224
    v_mfma_f32_32x32x16_bf16 v[24:39], v[48:51], v[40:43], v[24:39]
    s_waitcnt lgkmcnt(0)
    ds_read_b128 v[48:51], v10 offset:0
    ds_read_b64_tr_b16 v[40:41], v3 offset:40704
    ds_read_b64_tr_b16 v[42:43], v3 offset:40864
    v_mfma_f32_32x32x16_bf16 v[24:39], v[52:55], v[44:47], v[24:39]
    s_waitcnt lgkmcnt(0)
    ds_read_b128 v[52:55], v11 offset:0
    ds_read_b64_tr_b16 v[44:45], v3 offset:41344
    ds_read_b64_tr_b16 v[46:47], v3 offset:41504
    v_mfma_f32_32x32x16_bf16 v[24:39], v[48:51], v[40:43], v[24:39]
    s_waitcnt lgkmcnt(0)
    s_barrier
    ds_read_b128 v[48:51], v8 offset:36864
    ds_read_b64_tr_b16 v[40:41], v3 offset:41984
    ds_read_b64_tr_b16 v[42:43], v3 offset:42144
    v_mfma_f32_32x32x16_bf16 v[24:39], v[52:55], v[44:47], v[24:39]
    s_waitcnt lgkmcnt(0)
    ds_read_b128 v[52:55], v9 offset:36864
    ds_read_b64_tr_b16 v[44:45], v3 offset:42624
    ds_read_b64_tr_b16 v[46:47], v3 offset:42784
    v_mfma_f32_32x32x16_bf16 v[24:39], v[48:51], v[40:43], v[24:39]
    s_waitcnt lgkmcnt(0)
    ds_read_b128 v[48:51], v10 offset:36864
    ds_read_b64_tr_b16 v[40:41], v3 offset:43264
    ds_read_b64_tr_b16 v[42:43], v3 offset:43424
    v_mfma_f32_32x32x16_bf16 v[24:39], v[52:55], v[44:47], v[24:39]
    s_waitcnt lgkmcnt(0)
    ds_read_b128 v[52:55], v11 offset:36864
    ds_read_b64_tr_b16 v[44:45], v3 offset:43904
    ds_read_b64_tr_b16 v[46:47], v3 offset:44064
    v_mfma_f32_32x32x16_bf16 v[24:39], v[48:51], v[40:43], v[24:39]
    s_waitcnt lgkmcnt(0)
    s_barrier
    ds_read_b128 v[48:51], v4 offset:0
    ds_read_b64_tr_b16 v[40:41], v3 offset:44544
    ds_read_b64_tr_b16 v[42:43], v3 offset:44704
    v_mfma_f32_32x32x16_bf16 v[24:39], v[52:55], v[44:47], v[24:39]
    s_waitcnt lgkmcnt(0)
    ds_read_b128 v[52:55], v5 offset:0
    ds_read_b64_tr_b16 v[44:45], v3 offset:45184
    ds_read_b64_tr_b16 v[46:47], v3 offset:45344
    v_mfma_f32_32x32x16_bf16 v[24:39], v[48:51], v[40:43], v[24:39]
    s_waitcnt lgkmcnt(0)
    ds_read_b128 v[48:51], v6 offset:0
    ds_read_b64_tr_b16 v[40:41], v3 offset:45824
    ds_read_b64_tr_b16 v[42:43], v3 offset:45984
    v_mfma_f32_32x32x16_bf16 v[24:39], v[52:55], v[44:47], v[24:39]
    s_waitcnt lgkmcnt(0)
    ds_read_b128 v[52:55], v7 offset:0
    ds_read_b64_tr_b16 v[44:45], v3 offset:46464
    ds_read_b64_tr_b16 v[46:47], v3 offset:46624
    v_mfma_f32_32x32x16_bf16 v[24:39], v[48:51], v[40:43], v[24:39]
    s_waitcnt lgkmcnt(0)
    s_barrier
    ds_read_b128 v[48:51], v4 offset:36864
    ds_read_b64_tr_b16 v[40:41], v3 offset:47104
    ds_read_b64_tr_b16 v[42:43], v3 offset:47264
    v_mfma_f32_32x32x16_bf16 v[24:39], v[52:55], v[44:47], v[24:39]
    s_waitcnt lgkmcnt(0)
    ds_read_b128 v[52:55], v5 offset:36864
    ds_read_b64_tr_b16 v[44:45], v3 offset:47744
    ds_read_b64_tr_b16 v[46:47], v3 offset:47904
    v_mfma_f32_32x32x16_bf16 v[24:39], v[48:51], v[40:43], v[24:39]
    s_waitcnt lgkmcnt(0)
    ds_read_b128 v[48:51], v6 offset:36864
    ds_read_b64_tr_b16 v[40:41], v3 offset:48384
    ds_read_b64_tr_b16 v[42:43], v3 offset:48544
    v_mfma_f32_32x32x16_bf16 v[24:39], v[52:55], v[44:47], v[24:39]
    s_waitcnt lgkmcnt(0)
    ds_read_b128 v[52:55], v7 offset:36864
    ds_read_b64_tr_b16 v[44:45], v3 offset:49024
    ds_read_b64_tr_b16 v[46:47], v3 offset:49184
    v_mfma_f32_32x32x16_bf16 v[24:39], v[48:51], v[40:43], v[24:39]
    s_waitcnt lgkmcnt(0)
    v_mfma_f32_32x32x16_bf16 v[24:39], v[52:55], v[44:47], v[24:39]
    v_and_b32 v1, 31, v0
    s_lshl_b32 s64, s53, 5
    v_add_u32 v1, s64, v1
    v_lshlrev_b32 v1, 4, v1
    v_add_u32 v1, 152576, v1
    ds_read_b128 v[56:59], v1
    ds_read_b64_tr_b16 v[64:65], v3 offset:0
    ds_read_b64_tr_b16 v[66:67], v3 offset:160
    ds_read_b64_tr_b16 v[68:69], v3 offset:640
    ds_read_b64_tr_b16 v[70:71], v3 offset:800
    ds_read_b64_tr_b16 v[72:73], v3 offset:1280
    ds_read_b64_tr_b16 v[74:75], v3 offset:1440
    ds_read_b64_tr_b16 v[76:77], v3 offset:1920
    ds_read_b64_tr_b16 v[78:79], v3 offset:2080
    s_waitcnt lgkmcnt(0)
    v_dot2_f32_bf16 v19, v64, v13, v19
    v_dot2_f32_bf16 v20, v68, v13, v20
    v_dot2_f32_bf16 v21, v72, v13, v21
    v_dot2_f32_bf16 v22, v76, v13, v22
    v_dot2_f32_bf16 v19, v65, v13, v19
    v_dot2_f32_bf16 v20, v69, v13, v20
    v_dot2_f32_bf16 v21, v73, v13, v21
    v_dot2_f32_bf16 v22, v77, v13, v22
    v_dot2_f32_bf16 v19, v66, v13, v19
    v_dot2_f32_bf16 v20, v70, v13, v20
    v_dot2_f32_bf16 v21, v74, v13, v21
    v_dot2_f32_bf16 v22, v78, v13, v22
    v_dot2_f32_bf16 v19, v67, v13, v19
    v_dot2_f32_bf16 v20, v71, v13, v20
    v_dot2_f32_bf16 v21, v75, v13, v21
    v_dot2_f32_bf16 v22, v79, v13, v22
    ds_read_b64_tr_b16 v[64:65], v3 offset:2560
    ds_read_b64_tr_b16 v[66:67], v3 offset:2720
    ds_read_b64_tr_b16 v[68:69], v3 offset:3200
    ds_read_b64_tr_b16 v[70:71], v3 offset:3360
    ds_read_b64_tr_b16 v[72:73], v3 offset:3840
    ds_read_b64_tr_b16 v[74:75], v3 offset:4000
    ds_read_b64_tr_b16 v[76:77], v3 offset:4480
    ds_read_b64_tr_b16 v[78:79], v3 offset:4640
    s_waitcnt lgkmcnt(0)
    v_dot2_f32_bf16 v19, v64, v13, v19
    v_dot2_f32_bf16 v20, v68, v13, v20
    v_dot2_f32_bf16 v21, v72, v13, v21
    v_dot2_f32_bf16 v22, v76, v13, v22
    v_dot2_f32_bf16 v19, v65, v13, v19
    v_dot2_f32_bf16 v20, v69, v13, v20
    v_dot2_f32_bf16 v21, v73, v13, v21
    v_dot2_f32_bf16 v22, v77, v13, v22
    v_dot2_f32_bf16 v19, v66, v13, v19
    v_dot2_f32_bf16 v20, v70, v13, v20
    v_dot2_f32_bf16 v21, v74, v13, v21
    v_dot2_f32_bf16 v22, v78, v13, v22
    v_dot2_f32_bf16 v19, v67, v13, v19
    v_dot2_f32_bf16 v20, v71, v13, v20
    v_dot2_f32_bf16 v21, v75, v13, v21
    v_dot2_f32_bf16 v22, v79, v13, v22
    ds_read_b64_tr_b16 v[64:65], v3 offset:5120
    ds_read_b64_tr_b16 v[66:67], v3 offset:5280
    ds_read_b64_tr_b16 v[68:69], v3 offset:5760
    ds_read_b64_tr_b16 v[70:71], v3 offset:5920
    ds_read_b64_tr_b16 v[72:73], v3 offset:6400
    ds_read_b64_tr_b16 v[74:75], v3 offset:6560
    ds_read_b64_tr_b16 v[76:77], v3 offset:7040
    ds_read_b64_tr_b16 v[78:79], v3 offset:7200
    s_waitcnt lgkmcnt(0)
    v_dot2_f32_bf16 v19, v64, v13, v19
    v_dot2_f32_bf16 v20, v68, v13, v20
    v_dot2_f32_bf16 v21, v72, v13, v21
    v_dot2_f32_bf16 v22, v76, v13, v22
    v_dot2_f32_bf16 v19, v65, v13, v19
    v_dot2_f32_bf16 v20, v69, v13, v20
    v_dot2_f32_bf16 v21, v73, v13, v21
    v_dot2_f32_bf16 v22, v77, v13, v22
    v_dot2_f32_bf16 v19, v66, v13, v19
    v_dot2_f32_bf16 v20, v70, v13, v20
    v_dot2_f32_bf16 v21, v74, v13, v21
    v_dot2_f32_bf16 v22, v78, v13, v22
    v_dot2_f32_bf16 v19, v67, v13, v19
    v_dot2_f32_bf16 v20, v71, v13, v20
    v_dot2_f32_bf16 v21, v75, v13, v21
    v_dot2_f32_bf16 v22, v79, v13, v22
    ds_read_b64_tr_b16 v[64:65], v3 offset:7680
    ds_read_b64_tr_b16 v[66:67], v3 offset:7840
    ds_read_b64_tr_b16 v[68:69], v3 offset:8320
    ds_read_b64_tr_b16 v[70:71], v3 offset:8480
    ds_read_b64_tr_b16 v[72:73], v3 offset:8960
    ds_read_b64_tr_b16 v[74:75], v3 offset:9120
    ds_read_b64_tr_b16 v[76:77], v3 offset:9600
    ds_read_b64_tr_b16 v[78:79], v3 offset:9760
    s_waitcnt lgkmcnt(0)
    v_dot2_f32_bf16 v19, v64, v13, v19
    v_dot2_f32_bf16 v20, v68, v13, v20
    v_dot2_f32_bf16 v21, v72, v13, v21
    v_dot2_f32_bf16 v22, v76, v13, v22
    v_dot2_f32_bf16 v19, v65, v13, v19
    v_dot2_f32_bf16 v20, v69, v13, v20
    v_dot2_f32_bf16 v21, v73, v13, v21
    v_dot2_f32_bf16 v22, v77, v13, v22
    v_dot2_f32_bf16 v19, v66, v13, v19
    v_dot2_f32_bf16 v20, v70, v13, v20
    v_dot2_f32_bf16 v21, v74, v13, v21
    v_dot2_f32_bf16 v22, v78, v13, v22
    v_dot2_f32_bf16 v19, v67, v13, v19
    v_dot2_f32_bf16 v20, v71, v13, v20
    v_dot2_f32_bf16 v21, v75, v13, v21
    v_dot2_f32_bf16 v22, v79, v13, v22
    ds_read_b64_tr_b16 v[64:65], v3 offset:10240
    ds_read_b64_tr_b16 v[66:67], v3 offset:10400
    ds_read_b64_tr_b16 v[68:69], v3 offset:10880
    ds_read_b64_tr_b16 v[70:71], v3 offset:11040
    ds_read_b64_tr_b16 v[72:73], v3 offset:11520
    ds_read_b64_tr_b16 v[74:75], v3 offset:11680
    ds_read_b64_tr_b16 v[76:77], v3 offset:12160
    ds_read_b64_tr_b16 v[78:79], v3 offset:12320
    s_waitcnt lgkmcnt(0)
    v_dot2_f32_bf16 v19, v64, v13, v19
    v_dot2_f32_bf16 v20, v68, v13, v20
    v_dot2_f32_bf16 v21, v72, v13, v21
    v_dot2_f32_bf16 v22, v76, v13, v22
    v_dot2_f32_bf16 v19, v65, v13, v19
    v_dot2_f32_bf16 v20, v69, v13, v20
    v_dot2_f32_bf16 v21, v73, v13, v21
    v_dot2_f32_bf16 v22, v77, v13, v22
    v_dot2_f32_bf16 v19, v66, v13, v19
    v_dot2_f32_bf16 v20, v70, v13, v20
    v_dot2_f32_bf16 v21, v74, v13, v21
    v_dot2_f32_bf16 v22, v78, v13, v22
    v_dot2_f32_bf16 v19, v67, v13, v19
    v_dot2_f32_bf16 v20, v71, v13, v20
    v_dot2_f32_bf16 v21, v75, v13, v21
    v_dot2_f32_bf16 v22, v79, v13, v22
    ds_read_b64_tr_b16 v[64:65], v3 offset:36864
    ds_read_b64_tr_b16 v[66:67], v3 offset:37024
    ds_read_b64_tr_b16 v[68:69], v3 offset:37504
    ds_read_b64_tr_b16 v[70:71], v3 offset:37664
    ds_read_b64_tr_b16 v[72:73], v3 offset:38144
    ds_read_b64_tr_b16 v[74:75], v3 offset:38304
    ds_read_b64_tr_b16 v[76:77], v3 offset:38784
    ds_read_b64_tr_b16 v[78:79], v3 offset:38944
    s_waitcnt lgkmcnt(0)
    v_dot2_f32_bf16 v19, v64, v13, v19
    v_dot2_f32_bf16 v20, v68, v13, v20
    v_dot2_f32_bf16 v21, v72, v13, v21
    v_dot2_f32_bf16 v22, v76, v13, v22
    v_dot2_f32_bf16 v19, v65, v13, v19
    v_dot2_f32_bf16 v20, v69, v13, v20
    v_dot2_f32_bf16 v21, v73, v13, v21
    v_dot2_f32_bf16 v22, v77, v13, v22
    v_dot2_f32_bf16 v19, v66, v13, v19
    v_dot2_f32_bf16 v20, v70, v13, v20
    v_dot2_f32_bf16 v21, v74, v13, v21
    v_dot2_f32_bf16 v22, v78, v13, v22
    v_dot2_f32_bf16 v19, v67, v13, v19
    v_dot2_f32_bf16 v20, v71, v13, v20
    v_dot2_f32_bf16 v21, v75, v13, v21
    v_dot2_f32_bf16 v22, v79, v13, v22
    ds_read_b64_tr_b16 v[64:65], v3 offset:39424
    ds_read_b64_tr_b16 v[66:67], v3 offset:39584
    ds_read_b64_tr_b16 v[68:69], v3 offset:40064
    ds_read_b64_tr_b16 v[70:71], v3 offset:40224
    ds_read_b64_tr_b16 v[72:73], v3 offset:40704
    ds_read_b64_tr_b16 v[74:75], v3 offset:40864
    ds_read_b64_tr_b16 v[76:77], v3 offset:41344
    ds_read_b64_tr_b16 v[78:79], v3 offset:41504
    s_waitcnt lgkmcnt(0)
    v_dot2_f32_bf16 v19, v64, v13, v19
    v_dot2_f32_bf16 v20, v68, v13, v20
    v_dot2_f32_bf16 v21, v72, v13, v21
    v_dot2_f32_bf16 v22, v76, v13, v22
    v_dot2_f32_bf16 v19, v65, v13, v19
    v_dot2_f32_bf16 v20, v69, v13, v20
    v_dot2_f32_bf16 v21, v73, v13, v21
    v_dot2_f32_bf16 v22, v77, v13, v22
    v_dot2_f32_bf16 v19, v66, v13, v19
    v_dot2_f32_bf16 v20, v70, v13, v20
    v_dot2_f32_bf16 v21, v74, v13, v21
    v_dot2_f32_bf16 v22, v78, v13, v22
    v_dot2_f32_bf16 v19, v67, v13, v19
    v_dot2_f32_bf16 v20, v71, v13, v20
    v_dot2_f32_bf16 v21, v75, v13, v21
    v_dot2_f32_bf16 v22, v79, v13, v22
    ds_read_b64_tr_b16 v[64:65], v3 offset:41984
    ds_read_b64_tr_b16 v[66:67], v3 offset:42144
    ds_read_b64_tr_b16 v[68:69], v3 offset:42624
    ds_read_b64_tr_b16 v[70:71], v3 offset:42784
    ds_read_b64_tr_b16 v[72:73], v3 offset:43264
    ds_read_b64_tr_b16 v[74:75], v3 offset:43424
    ds_read_b64_tr_b16 v[76:77], v3 offset:43904
    ds_read_b64_tr_b16 v[78:79], v3 offset:44064
    s_waitcnt lgkmcnt(0)
    v_dot2_f32_bf16 v19, v64, v13, v19
    v_dot2_f32_bf16 v20, v68, v13, v20
    v_dot2_f32_bf16 v21, v72, v13, v21
    v_dot2_f32_bf16 v22, v76, v13, v22
    v_dot2_f32_bf16 v19, v65, v13, v19
    v_dot2_f32_bf16 v20, v69, v13, v20
    v_dot2_f32_bf16 v21, v73, v13, v21
    v_dot2_f32_bf16 v22, v77, v13, v22
    v_dot2_f32_bf16 v19, v66, v13, v19
    v_dot2_f32_bf16 v20, v70, v13, v20
    v_dot2_f32_bf16 v21, v74, v13, v21
    v_dot2_f32_bf16 v22, v78, v13, v22
    v_dot2_f32_bf16 v19, v67, v13, v19
    v_dot2_f32_bf16 v20, v71, v13, v20
    v_dot2_f32_bf16 v21, v75, v13, v21
    v_dot2_f32_bf16 v22, v79, v13, v22
    ds_read_b64_tr_b16 v[64:65], v3 offset:44544
    ds_read_b64_tr_b16 v[66:67], v3 offset:44704
    ds_read_b64_tr_b16 v[68:69], v3 offset:45184
    ds_read_b64_tr_b16 v[70:71], v3 offset:45344
    ds_read_b64_tr_b16 v[72:73], v3 offset:45824
    ds_read_b64_tr_b16 v[74:75], v3 offset:45984
    ds_read_b64_tr_b16 v[76:77], v3 offset:46464
    ds_read_b64_tr_b16 v[78:79], v3 offset:46624
    s_waitcnt lgkmcnt(0)
    v_dot2_f32_bf16 v19, v64, v13, v19
    v_dot2_f32_bf16 v20, v68, v13, v20
    v_dot2_f32_bf16 v21, v72, v13, v21
    v_dot2_f32_bf16 v22, v76, v13, v22
    v_dot2_f32_bf16 v19, v65, v13, v19
    v_dot2_f32_bf16 v20, v69, v13, v20
    v_dot2_f32_bf16 v21, v73, v13, v21
    v_dot2_f32_bf16 v22, v77, v13, v22
    v_dot2_f32_bf16 v19, v66, v13, v19
    v_dot2_f32_bf16 v20, v70, v13, v20
    v_dot2_f32_bf16 v21, v74, v13, v21
    v_dot2_f32_bf16 v22, v78, v13, v22
    v_dot2_f32_bf16 v19, v67, v13, v19
    v_dot2_f32_bf16 v20, v71, v13, v20
    v_dot2_f32_bf16 v21, v75, v13, v21
    v_dot2_f32_bf16 v22, v79, v13, v22
    ds_read_b64_tr_b16 v[64:65], v3 offset:47104
    ds_read_b64_tr_b16 v[66:67], v3 offset:47264
    ds_read_b64_tr_b16 v[68:69], v3 offset:47744
    ds_read_b64_tr_b16 v[70:71], v3 offset:47904
    ds_read_b64_tr_b16 v[72:73], v3 offset:48384
    ds_read_b64_tr_b16 v[74:75], v3 offset:48544
    ds_read_b64_tr_b16 v[76:77], v3 offset:49024
    ds_read_b64_tr_b16 v[78:79], v3 offset:49184
    s_waitcnt lgkmcnt(0)
    v_dot2_f32_bf16 v19, v64, v13, v19
    v_dot2_f32_bf16 v20, v68, v13, v20
    v_dot2_f32_bf16 v21, v72, v13, v21
    v_dot2_f32_bf16 v22, v76, v13, v22
    v_dot2_f32_bf16 v19, v65, v13, v19
    v_dot2_f32_bf16 v20, v69, v13, v20
    v_dot2_f32_bf16 v21, v73, v13, v21
    v_dot2_f32_bf16 v22, v77, v13, v22
    v_dot2_f32_bf16 v19, v66, v13, v19
    v_dot2_f32_bf16 v20, v70, v13, v20
    v_dot2_f32_bf16 v21, v74, v13, v21
    v_dot2_f32_bf16 v22, v78, v13, v22
    v_dot2_f32_bf16 v19, v67, v13, v19
    v_dot2_f32_bf16 v20, v71, v13, v20
    v_dot2_f32_bf16 v21, v75, v13, v21
    v_dot2_f32_bf16 v22, v79, v13, v22
    s_nop 3
    v_add_f32 v19, v19, v20
    v_add_f32 v21, v21, v22
    v_add_f32 v18, v19, v21
    v_mov_b32 v1, v18
    s_nop 1
    v_permlane32_swap_b32 v18, v1
    s_nop 1
    v_add_f32 v18, v18, v1
    v_cmp_gt_u32 vcc, 32, v0
    s_nop 1
    v_cndmask_b32 v18, 0, v18, vcc
    v_mov_b32 v1, 0
    v_sub_f32 v80, 0, v56
    v_cvt_pk_bf16_f32 v83, v80, v80
    v_and_b32 v81, 0xffff0000, v83
    v_sub_f32 v82, v80, v81
    v_cvt_pk_bf16_f32 v48, v81, v82
    v_cvt_pk_bf16_f32 v83, v58, v58
    v_and_b32 v80, 0xffff0000, v83
    v_sub_f32 v82, v58, v80
    v_cvt_pk_bf16_f32 v49, v81, v80
    v_mov_b32 v51, 0
    v_cvt_pk_bf16_f32 v50, v82, v51
    v_cvt_pk_bf16_f32 v40, v18, v18
    v_and_b32 v80, 0xffff0000, v40
    v_sub_f32 v81, v18, v80
    v_cvt_pk_bf16_f32 v41, v81, v1
    v_mov_b32 v43, 0
    v_cvt_pk_bf16_f32 v42, v1, v43
    s_nop 1
    v_mfma_f32_32x32x16_bf16 v[24:39], v[48:51], v[40:43], v[24:39]
    v_and_b32 v1, 31, v0
    s_lshl_b32 s64, s53, 5
    v_add_u32 v1, s64, v1
    v_lshlrev_b32 v1, 2, v1
    v_add_u32 v1, 154624, v1
    ds_write_b32 v1, v57
    s_waitcnt lgkmcnt(0)
    v_lshrrev_b32 v1, 5, v0
    v_lshlrev_b32 v1, 4, v1
    s_lshl_b32 s64, s53, 7
    v_add_u32 v1, s64, v1
    v_add_u32 v1, 154624, v1
    ds_read_b128 v[84:87], v1 offset:0
    ds_read_b128 v[88:91], v1 offset:32
    ds_read_b128 v[92:95], v1 offset:64
    ds_read_b128 v[96:99], v1 offset:96
    s_waitcnt lgkmcnt(0)
    s_nop 15
    v_mul_f32 v24, v24, v84
    v_mul_f32 v25, v25, v85
    v_mul_f32 v26, v26, v86
    v_mul_f32 v27, v27, v87
    v_mul_f32 v28, v28, v88
    v_mul_f32 v29, v29, v89
    v_mul_f32 v30, v30, v90
    v_mul_f32 v31, v31, v91
    v_mul_f32 v32, v32, v92
    v_mul_f32 v33, v33, v93
    v_mul_f32 v34, v34, v94
    v_mul_f32 v35, v35, v95
    v_mul_f32 v36, v36, v96
    v_mul_f32 v37, v37, v97
    v_mul_f32 v38, v38, v98
    v_mul_f32 v39, v39, v99
    v_cvt_pk_bf16_f32 v24, v24, v25
    v_cvt_pk_bf16_f32 v25, v26, v27
    v_cvt_pk_bf16_f32 v26, v28, v29
    v_cvt_pk_bf16_f32 v27, v30, v31
    v_cvt_pk_bf16_f32 v28, v32, v33
    v_cvt_pk_bf16_f32 v29, v34, v35
    v_cvt_pk_bf16_f32 v30, v36, v37
    v_cvt_pk_bf16_f32 v31, v38, v39
    v_and_b32 v1, 31, v0
    v_lshrrev_b32 v2, 5, v0
    v_mul_u32_u24 v2, 20, v2
    v_add_u32 v2, v2, v1
    v_lshlrev_b32 v2, 4, v2
    v_cmp_gt_u32 vcc, 20, v1
    s_and_saveexec_b64 s[4:5], vcc
    buffer_store_dwordx4 v[24:27], v2, s[16:19], s62 offen offset:1280 sc0 sc1
    buffer_store_dwordx4 v[28:31], v2, s[16:19], s62 offen offset:1920 sc0 sc1
    s_endpgm
K1_LOADKV:
    s_setprio 3
    s_lshl_b32 s61, s53, 12
    s_mul_i32 s60, s53, 5120
    s_mov_b32 s69, 0
    s_lshl_b32 s64, s55, 7
    s_lshl_b32 s65, s53, 5
    s_add_u32 s64, s64, s65
    v_lshrrev_b32 v1, 3, v0
    v_add_u32 v1, s64, v1
    v_mul_u32_u24 v3, 1280, v1
    v_and_b32 v1, 7, v0
    v_lshrrev_b32 v4, 4, v0
    v_xor_b32 v1, v1, v4
    v_lshlrev_b32 v1, 4, v1
    v_xor_b32 v4, 64, v1
    v_add_u32 v4, v3, v4
    v_add_u32 v4, 10240, v4
    v_add_u32 v3, v3, v1
    v_lshlrev_b32 v5, 4, v0
    s_waitcnt lgkmcnt(0)
    s_mov_b32 s42, s78
    s_mov_b32 s43, s79
    s_mov_b32 s6, s76
    s_mov_b32 s7, s77
    s_mov_b32 s8, s24
    s_and_b32 s9, s25, 0xffff
    s_mov_b32 s10, 2621440
    s_mov_b32 s11, 0x20000
    s_mov_b32 s16, s42
    s_and_b32 s17, s43, 0xffff
    s_mov_b32 s18, 21872640
    s_mov_b32 s19, 0x20000
    s_lshr_b32 s64, s53, 1
    s_cmp_eq_u32 s64, 0
    s_cselect_b32 s12, s28, s30
    s_cselect_b32 s13, s29, s31
    s_and_b32 s13, s13, 0xffff
    s_mov_b32 s14, 25600
    s_mov_b32 s15, 0x20000
    s_and_b32 s65, s53, 1
    s_mul_i32 s58, s65, 12800
    s_mul_i32 s60, s53, 36864
    s_lshl_b32 s70, s69, 7
    s_add_u32 m0, s61, 20480
    s_add_u32 s59, s70, 0
    buffer_load_dwordx4 v3, s[8:11], s59 offen lds
    s_add_u32 m0, s61, 21504
    s_add_u32 s59, s70, 0
    buffer_load_dwordx4 v4, s[8:11], s59 offen lds
    s_add_u32 m0, s61, 22528
    s_add_u32 s59, s70, 20480
    buffer_load_dwordx4 v3, s[8:11], s59 offen lds
    s_add_u32 m0, s61, 23552
    s_add_u32 s59, s70, 20480
    buffer_load_dwordx4 v4, s[8:11], s59 offen lds
    s_add_u32 s69, s69, 1
    s_cmp_eq_u32 s69, 10
    s_cselect_b32 s69, 0, s69
    s_add_u32 m0, s60, 0
    s_add_u32 s64, s58, 0
    buffer_load_dwordx4 v5, s[12:15], s64 offen lds
    s_add_u32 m0, s60, 1024
    s_add_u32 s64, s58, 1024
    buffer_load_dwordx4 v5, s[12:15], s64 offen lds
    s_add_u32 m0, s60, 2048
    s_add_u32 s64, s58, 2048
    buffer_load_dwordx4 v5, s[12:15], s64 offen lds
    s_add_u32 m0, s60, 3072
    s_add_u32 s64, s58, 3072
    buffer_load_dwordx4 v5, s[12:15], s64 offen lds
    s_add_u32 m0, s60, 4096
    s_add_u32 s64, s58, 4096
    buffer_load_dwordx4 v5, s[12:15], s64 offen lds
    s_add_u32 m0, s60, 5120
    s_add_u32 s64, s58, 5120
    buffer_load_dwordx4 v5, s[12:15], s64 offen lds
    s_add_u32 m0, s60, 6144
    s_add_u32 s64, s58, 6144
    buffer_load_dwordx4 v5, s[12:15], s64 offen lds
    s_add_u32 m0, s60, 7168
    s_add_u32 s64, s58, 7168
    buffer_load_dwordx4 v5, s[12:15], s64 offen lds
    s_add_u32 m0, s60, 8192
    s_add_u32 s64, s58, 8192
    buffer_load_dwordx4 v5, s[12:15], s64 offen lds
    s_add_u32 m0, s60, 9216
    s_add_u32 s64, s58, 9216
    buffer_load_dwordx4 v5, s[12:15], s64 offen lds
    s_add_u32 m0, s60, 10240
    s_add_u32 s64, s58, 10240
    buffer_load_dwordx4 v5, s[12:15], s64 offen lds
    s_add_u32 m0, s60, 11264
    s_add_u32 s64, s58, 11264
    buffer_load_dwordx4 v5, s[12:15], s64 offen lds
    s_add_u32 m0, s60, 12288
    s_add_u32 s64, s58, 12288
    buffer_load_dwordx4 v5, s[12:15], s64 offen lds
    s_lshl_b32 s70, s69, 7
    s_add_u32 m0, s61, 57344
    s_add_u32 s59, s70, 0
    buffer_load_dwordx4 v3, s[8:11], s59 offen lds
    s_add_u32 m0, s61, 58368
    s_add_u32 s59, s70, 0
    buffer_load_dwordx4 v4, s[8:11], s59 offen lds
    s_add_u32 m0, s61, 59392
    s_add_u32 s59, s70, 20480
    buffer_load_dwordx4 v3, s[8:11], s59 offen lds
    s_add_u32 m0, s61, 60416
    s_add_u32 s59, s70, 20480
    buffer_load_dwordx4 v4, s[8:11], s59 offen lds
    s_add_u32 s69, s69, 1
    s_cmp_eq_u32 s69, 10
    s_cselect_b32 s69, 0, s69
    s_waitcnt vmcnt(4)
    s_barrier
    s_lshl_b32 s70, s69, 7
    s_add_u32 m0, s61, 94208
    s_add_u32 s59, s70, 0
    buffer_load_dwordx4 v3, s[8:11], s59 offen lds
    s_add_u32 m0, s61, 95232
    s_add_u32 s59, s70, 0
    buffer_load_dwordx4 v4, s[8:11], s59 offen lds
    s_add_u32 m0, s61, 96256
    s_add_u32 s59, s70, 20480
    buffer_load_dwordx4 v3, s[8:11], s59 offen lds
    s_add_u32 m0, s61, 97280
    s_add_u32 s59, s70, 20480
    buffer_load_dwordx4 v4, s[8:11], s59 offen lds
    s_add_u32 s69, s69, 1
    s_cmp_eq_u32 s69, 10
    s_cselect_b32 s69, 0, s69
    s_lshl_b32 s70, s69, 7
    s_add_u32 m0, s61, 131072
    s_add_u32 s59, s70, 0
    buffer_load_dwordx4 v3, s[8:11], s59 offen lds
    s_add_u32 m0, s61, 132096
    s_add_u32 s59, s70, 0
    buffer_load_dwordx4 v4, s[8:11], s59 offen lds
    s_add_u32 m0, s61, 133120
    s_add_u32 s59, s70, 20480
    buffer_load_dwordx4 v3, s[8:11], s59 offen lds
    s_add_u32 m0, s61, 134144
    s_add_u32 s59, s70, 20480
    buffer_load_dwordx4 v4, s[8:11], s59 offen lds
    s_add_u32 s69, s69, 1
    s_cmp_eq_u32 s69, 10
    s_cselect_b32 s69, 0, s69
    s_waitcnt vmcnt(8)
    s_barrier
    s_lshl_b32 s70, s69, 7
    s_add_u32 m0, s61, 20480
    s_add_u32 s59, s70, 0
    buffer_load_dwordx4 v3, s[8:11], s59 offen lds
    s_add_u32 m0, s61, 21504
    s_add_u32 s59, s70, 0
    buffer_load_dwordx4 v4, s[8:11], s59 offen lds
    s_add_u32 m0, s61, 22528
    s_add_u32 s59, s70, 20480
    buffer_load_dwordx4 v3, s[8:11], s59 offen lds
    s_add_u32 m0, s61, 23552
    s_add_u32 s59, s70, 20480
    buffer_load_dwordx4 v4, s[8:11], s59 offen lds
    s_add_u32 s69, s69, 1
    s_cmp_eq_u32 s69, 10
    s_cselect_b32 s69, 0, s69
    s_waitcnt vmcnt(8)
    s_barrier
    s_lshl_b32 s70, s69, 7
    s_add_u32 m0, s61, 57344
    s_add_u32 s59, s70, 0
    buffer_load_dwordx4 v3, s[8:11], s59 offen lds
    s_add_u32 m0, s61, 58368
    s_add_u32 s59, s70, 0
    buffer_load_dwordx4 v4, s[8:11], s59 offen lds
    s_add_u32 m0, s61, 59392
    s_add_u32 s59, s70, 20480
    buffer_load_dwordx4 v3, s[8:11], s59 offen lds
    s_add_u32 m0, s61, 60416
    s_add_u32 s59, s70, 20480
    buffer_load_dwordx4 v4, s[8:11], s59 offen lds
    s_add_u32 s69, s69, 1
    s_cmp_eq_u32 s69, 10
    s_cselect_b32 s69, 0, s69
    s_waitcnt vmcnt(8)
    s_barrier
    s_lshl_b32 s70, s69, 7
    s_add_u32 m0, s61, 94208
    s_add_u32 s59, s70, 0
    buffer_load_dwordx4 v3, s[8:11], s59 offen lds
    s_add_u32 m0, s61, 95232
    s_add_u32 s59, s70, 0
    buffer_load_dwordx4 v4, s[8:11], s59 offen lds
    s_add_u32 m0, s61, 96256
    s_add_u32 s59, s70, 20480
    buffer_load_dwordx4 v3, s[8:11], s59 offen lds
    s_add_u32 m0, s61, 97280
    s_add_u32 s59, s70, 20480
    buffer_load_dwordx4 v4, s[8:11], s59 offen lds
    s_add_u32 s69, s69, 1
    s_cmp_eq_u32 s69, 10
    s_cselect_b32 s69, 0, s69
    s_waitcnt vmcnt(8)
    s_barrier
    s_lshl_b32 s70, s69, 7
    s_add_u32 m0, s61, 131072
    s_add_u32 s59, s70, 0
    buffer_load_dwordx4 v3, s[8:11], s59 offen lds
    s_add_u32 m0, s61, 132096
    s_add_u32 s59, s70, 0
    buffer_load_dwordx4 v4, s[8:11], s59 offen lds
    s_add_u32 m0, s61, 133120
    s_add_u32 s59, s70, 20480
    buffer_load_dwordx4 v3, s[8:11], s59 offen lds
    s_add_u32 m0, s61, 134144
    s_add_u32 s59, s70, 20480
    buffer_load_dwordx4 v4, s[8:11], s59 offen lds
    s_add_u32 s69, s69, 1
    s_cmp_eq_u32 s69, 10
    s_cselect_b32 s69, 0, s69
    s_waitcnt vmcnt(8)
    s_barrier
    s_lshl_b32 s70, s69, 7
    s_add_u32 m0, s61, 20480
    s_add_u32 s59, s70, 0
    buffer_load_dwordx4 v3, s[8:11], s59 offen lds
    s_add_u32 m0, s61, 21504
    s_add_u32 s59, s70, 0
    buffer_load_dwordx4 v4, s[8:11], s59 offen lds
    s_add_u32 m0, s61, 22528
    s_add_u32 s59, s70, 20480
    buffer_load_dwordx4 v3, s[8:11], s59 offen lds
    s_add_u32 m0, s61, 23552
    s_add_u32 s59, s70, 20480
    buffer_load_dwordx4 v4, s[8:11], s59 offen lds
    s_add_u32 s69, s69, 1
    s_cmp_eq_u32 s69, 10
    s_cselect_b32 s69, 0, s69
    s_waitcnt vmcnt(8)
    s_barrier
    s_lshl_b32 s70, s69, 7
    s_add_u32 m0, s61, 57344
    s_add_u32 s59, s70, 0
    buffer_load_dwordx4 v3, s[8:11], s59 offen lds
    s_add_u32 m0, s61, 58368
    s_add_u32 s59, s70, 0
    buffer_load_dwordx4 v4, s[8:11], s59 offen lds
    s_add_u32 m0, s61, 59392
    s_add_u32 s59, s70, 20480
    buffer_load_dwordx4 v3, s[8:11], s59 offen lds
    s_add_u32 m0, s61, 60416
    s_add_u32 s59, s70, 20480
    buffer_load_dwordx4 v4, s[8:11], s59 offen lds
    s_add_u32 s69, s69, 1
    s_cmp_eq_u32 s69, 10
    s_cselect_b32 s69, 0, s69
    s_waitcnt vmcnt(8)
    s_barrier
    s_waitcnt vmcnt(4)
    s_barrier
    s_waitcnt vmcnt(0)
    s_barrier
    s_mul_i32 s64, s2, 10240
    s_lshl_b32 s65, s53, 10
    s_add_u32 s64, s64, s65
    s_add_u32 s64, s64, 12894208
    v_mov_b32 v8, -1
    v_mov_b32 v9, -1
    v_mov_b32 v10, -1
    v_mov_b32 v11, -1
    v_lshlrev_b32 v1, 4, v0
    buffer_store_dwordx4 v[8:11], v1, s[16:19], s64 offen sc0 sc1
    s_add_u32 s64, s64, 4096
    buffer_store_dwordx4 v[8:11], v1, s[16:19], s64 offen sc0 sc1
    s_cmp_ge_u32 s53, 2
    s_cbranch_scc1 K1_NFK
    s_add_u32 s64, s64, 4096
    buffer_store_dwordx4 v[8:11], v1, s[16:19], s64 offen sc0 sc1
K1_NFK:
    s_endpgm
K1_END:
    s_endpgm
.globl k2_kernel
.p2align 8
.type k2_kernel,@function
k2_kernel:
    s_cmp_ge_u32 s2, 256
    s_cbranch_scc1 K2_END
    s_load_dwordx2 s[4:5], s[0:1], 96
    s_load_dwordx2 s[6:7], s[0:1], 0
    s_load_dwordx4 s[24:27], s[0:1], 72
    v_lshrrev_b32 v1, 6, v0
    v_and_b32 v0, 63, v0
    v_readfirstlane_b32 s40, v1
    s_and_b32 s52, s2, 31
    s_lshr_b32 s53, s2, 5
    s_lshr_b32 s43, s53, 2
    s_lshl_b32 s55, s52, 1
    s_add_u32 s55, s55, s43
    s_and_b32 s48, s53, 3
    s_sub_u32 s47, s40, 8
    s_cmp_ge_u32 s40, 8
    s_cbranch_scc1 K2_GEMM
    s_lshr_b32 s45, s40, 2
    s_lshl_b32 s41, s52, 1
    s_add_u32 s41, s41, s45
    s_and_b32 s45, s40, 3
    s_lshl_b32 s42, s53, 2
    s_add_u32 s42, s42, s45
    v_and_b32 v3, 31, v0
    v_lshrrev_b32 v2, 5, v0
    s_mul_i32 s43, s42, 20
    s_mul_i32 s44, s41, 40960
    v_lshlrev_b32 v4, 2, v2
    v_add_u32 v4, s43, v4
    v_lshrrev_b32 v5, 4, v4
    v_lshlrev_b32 v5, 10, v5
    v_bfe_u32 v1, v4, 2, 1
    v_lshl_add_u32 v1, v1, 5, v3
    v_lshl_add_u32 v5, v1, 4, v5
    v_bfe_u32 v1, v4, 3, 1
    v_lshl_add_u32 v5, v1, 3, v5
    v_add_u32 v5, s44, v5
    v_add_u32 v4, 8, v4
    v_lshrrev_b32 v6, 4, v4
    v_lshlrev_b32 v6, 10, v6
    v_bfe_u32 v1, v4, 2, 1
    v_lshl_add_u32 v1, v1, 5, v3
    v_lshl_add_u32 v6, v1, 4, v6
    v_bfe_u32 v1, v4, 3, 1
    v_lshl_add_u32 v6, v1, 3, v6
    v_add_u32 v6, s44, v6
    v_mov_b32 v4, s43
    v_add_u32 v4, 16, v4
    v_lshrrev_b32 v7, 4, v4
    v_lshlrev_b32 v7, 10, v7
    v_bfe_u32 v1, v4, 2, 1
    v_lshl_add_u32 v1, v1, 5, v3
    v_lshl_add_u32 v7, v1, 4, v7
    v_bfe_u32 v1, v4, 3, 1
    v_lshl_add_u32 v7, v1, 3, v7
    v_add_u32 v7, s44, v7
    s_waitcnt lgkmcnt(0)
    s_mov_b32 s8, s4
    s_and_b32 s9, s5, 0xffff
    s_mov_b32 s10, 21872640
    s_mov_b32 s11, 0x20000
    s_mov_b32 s45, 0
    buffer_load_dwordx2 v[84:85], v5, s[8:11], s45 offen
    buffer_load_dwordx2 v[86:87], v6, s[8:11], s45 offen
    buffer_load_dwordx2 v[88:89], v7, s[8:11], s45 offen
    s_mov_b32 s12, s6
    s_and_b32 s13, s7, 0xffff
    s_mov_b32 s14, 2621440
    s_mov_b32 s15, 0x20000
    s_mov_b32 s16, s24
    s_and_b32 s17, s25, 0xffff
    s_mov_b32 s18, 1280
    s_mov_b32 s19, 0x20000
    s_mov_b32 s20, s26
    s_and_b32 s21, s27, 0xffff
    s_mov_b32 s22, 2621440
    s_mov_b32 s23, 0x20000
    v_lshlrev_b32 v8, 4, v0
    v_mov_b32 v9, v8
    v_lshlrev_b32 v10, 3, v3
    v_add_u32 v10, 1024, v10
    v_lshrrev_b32 v2, 5, v0
    v_mul_u32_u24 v11, 20, v2
    v_add_u32 v11, v11, v3
    v_lshlrev_b32 v11, 4, v11
    v_add_u32 v11, 1280, v11
    v_mov_b32 v52, 0
    v_mov_b32 v53, 0
    v_mov_b32 v54, 0
    v_mov_b32 v55, 0
    v_mov_b32 v56, 0
    v_mov_b32 v57, 0
    v_mov_b32 v58, 0
    v_mov_b32 v59, 0
    v_mov_b32 v60, 0
    v_mov_b32 v61, 0
    v_mov_b32 v62, 0
    v_mov_b32 v63, 0
    v_mov_b32 v64, 0
    v_mov_b32 v65, 0
    v_mov_b32 v66, 0
    v_mov_b32 v67, 0
    v_mov_b32 v44, 0
    v_mov_b32 v45, 0
    v_mov_b32 v46, 0
    v_mov_b32 v47, 0
    v_mov_b32 v48, 0
    v_mov_b32 v49, 0
    v_mov_b32 v50, 0
    v_mov_b32 v51, 0
    s_mov_b32 s58, 0x000fffff
    s_mov_b32 s59, 0x000fffff
    s_mov_b32 s54, 0
    v_cmp_eq_u32 vcc, 20, v3
    v_mov_b32 v1, 0x3f803f80
    s_nop 0
    v_cndmask_b32 v76, 0, v1, vcc
    v_cndmask_b32 v80, 0, v1, vcc
    v_cndmask_b32 v77, 0, v1, vcc
    v_cndmask_b32 v81, 0, v1, vcc
    v_cndmask_b32 v78, 0, v1, vcc
    v_cndmask_b32 v82, 0, v1, vcc
    v_cndmask_b32 v79, 0, v1, vcc
    v_cndmask_b32 v83, 0, v1, vcc
    s_waitcnt vmcnt(0)
    v_cmp_gt_u32 vcc, 32, v0
    s_nop 1
    v_cndmask_b32 v88, 0, v88, vcc
    v_cndmask_b32 v89, 0, v89, vcc
    s_barrier
    ds_read_b128 v[68:71], v9
    ds_read_b64 v[72:73], v10
    s_waitcnt lgkmcnt(0)
    v_mfma_f32_32x32x16_bf16 v[12:27], v[68:71], v[84:87], 0
    v_mfma_f32_32x32x8_bf16 v[12:27], v[72:73], v[88:89], v[12:27]
    ds_read_b128 v[68:71], v9 offset:2560
    ds_read_b64 v[72:73], v10 offset:2560
    s_mov_b64 exec, s[58:59]
    ds_read_b128 v[80:83], v11
    ds_read_b128 v[76:79], v11
    s_mov_b64 exec, -1
    s_mov_b32 s46, 0
    s_nop 15
    s_cmp_ge_u32 s40, 4
    s_cbranch_scc1 K2_LOOPB
K2_LOOPA:
    s_setprio 3
    s_waitcnt lgkmcnt(2)
    v_mfma_f32_32x32x16_bf16 v[28:43], v[68:71], v[84:87], 0
    ds_read_b128 v[68:71], v9 offset:5120
    v_exp_f32 v12, v12
    v_exp_f32 v13, v13
    v_exp_f32 v14, v14
    v_cvt_pk_bf16_f32 v44, v12, v13
    v_exp_f32 v15, v15
    v_mfma_f32_32x32x8_bf16 v[28:43], v[72:73], v[88:89], v[28:43]
    v_cvt_pk_bf16_f32 v45, v14, v15
    ds_read_b64 v[72:73], v10 offset:5120
    v_exp_f32 v16, v16
    v_exp_f32 v17, v17
    v_exp_f32 v18, v18
    v_cvt_pk_bf16_f32 v46, v16, v17
    v_exp_f32 v19, v19
    s_waitcnt lgkmcnt(2)
    v_cvt_pk_bf16_f32 v47, v18, v19
    v_mfma_f32_32x32x16_bf16 v[52:67], v[80:83], v[48:51], v[52:67]
    v_exp_f32 v20, v20
    v_exp_f32 v21, v21
    v_exp_f32 v22, v22
    v_cvt_pk_bf16_f32 v48, v20, v21
    v_exp_f32 v23, v23
    s_setprio 0
    v_mfma_f32_32x32x16_bf16 v[52:67], v[76:79], v[44:47], v[52:67]
    v_cvt_pk_bf16_f32 v49, v22, v23
    s_mov_b64 exec, s[58:59]
    ds_read_b128 v[80:83], v11 offset:640
    ds_read_b128 v[76:79], v11 offset:2560
    s_mov_b64 exec, -1
    v_exp_f32 v24, v24
    v_exp_f32 v25, v25
    v_exp_f32 v26, v26
    v_cvt_pk_bf16_f32 v50, v24, v25
    v_exp_f32 v27, v27
    s_setprio 3
    s_waitcnt lgkmcnt(2)
    v_cvt_pk_bf16_f32 v51, v26, v27
    v_mfma_f32_32x32x16_bf16 v[12:27], v[68:71], v[84:87], 0
    ds_read_b128 v[68:71], v9 offset:7680
    v_exp_f32 v28, v28
    v_exp_f32 v29, v29
    v_exp_f32 v30, v30
    v_cvt_pk_bf16_f32 v44, v28, v29
    v_exp_f32 v31, v31
    v_mfma_f32_32x32x8_bf16 v[12:27], v[72:73], v[88:89], v[12:27]
    v_cvt_pk_bf16_f32 v45, v30, v31
    ds_read_b64 v[72:73], v10 offset:7680
    v_exp_f32 v32, v32
    v_exp_f32 v33, v33
    v_exp_f32 v34, v34
    v_cvt_pk_bf16_f32 v46, v32, v33
    v_exp_f32 v35, v35
    s_waitcnt lgkmcnt(2)
    v_cvt_pk_bf16_f32 v47, v34, v35
    v_mfma_f32_32x32x16_bf16 v[52:67], v[80:83], v[48:51], v[52:67]
    v_exp_f32 v36, v36
    v_exp_f32 v37, v37
    v_exp_f32 v38, v38
    v_cvt_pk_bf16_f32 v48, v36, v37
    v_exp_f32 v39, v39
    s_setprio 0
    v_mfma_f32_32x32x16_bf16 v[52:67], v[76:79], v[44:47], v[52:67]
    v_cvt_pk_bf16_f32 v49, v38, v39
    s_mov_b64 exec, s[58:59]
    ds_read_b128 v[80:83], v11 offset:3200
    ds_read_b128 v[76:79], v11 offset:5120
    s_mov_b64 exec, -1
    v_exp_f32 v40, v40
    v_exp_f32 v41, v41
    v_exp_f32 v42, v42
    v_cvt_pk_bf16_f32 v50, v40, v41
    v_exp_f32 v43, v43
    s_setprio 3
    s_waitcnt lgkmcnt(2)
    v_cvt_pk_bf16_f32 v51, v42, v43
    v_mfma_f32_32x32x16_bf16 v[28:43], v[68:71], v[84:87], 0
    ds_read_b128 v[68:71], v9 offset:10240
    v_exp_f32 v12, v12
    v_exp_f32 v13, v13
    v_exp_f32 v14, v14
    v_cvt_pk_bf16_f32 v44, v12, v13
    v_exp_f32 v15, v15
    v_mfma_f32_32x32x8_bf16 v[28:43], v[72:73], v[88:89], v[28:43]
    v_cvt_pk_bf16_f32 v45, v14, v15
    ds_read_b64 v[72:73], v10 offset:10240
    v_exp_f32 v16, v16
    v_exp_f32 v17, v17
    v_exp_f32 v18, v18
    v_cvt_pk_bf16_f32 v46, v16, v17
    v_exp_f32 v19, v19
    s_waitcnt lgkmcnt(2)
    v_cvt_pk_bf16_f32 v47, v18, v19
    v_mfma_f32_32x32x16_bf16 v[52:67], v[80:83], v[48:51], v[52:67]
    v_exp_f32 v20, v20
    v_exp_f32 v21, v21
    v_exp_f32 v22, v22
    v_cvt_pk_bf16_f32 v48, v20, v21
    v_exp_f32 v23, v23
    s_setprio 0
    v_mfma_f32_32x32x16_bf16 v[52:67], v[76:79], v[44:47], v[52:67]
    v_cvt_pk_bf16_f32 v49, v22, v23
    s_mov_b64 exec, s[58:59]
    ds_read_b128 v[80:83], v11 offset:5760
    ds_read_b128 v[76:79], v11 offset:7680
    s_mov_b64 exec, -1
    v_exp_f32 v24, v24
    v_exp_f32 v25, v25
    v_exp_f32 v26, v26
    v_cvt_pk_bf16_f32 v50, v24, v25
    v_exp_f32 v27, v27
    s_setprio 3
    s_waitcnt lgkmcnt(2)
    v_cvt_pk_bf16_f32 v51, v26, v27
    v_mfma_f32_32x32x16_bf16 v[12:27], v[68:71], v[84:87], 0
    ds_read_b128 v[68:71], v9 offset:12800
    v_exp_f32 v28, v28
    v_exp_f32 v29, v29
    v_exp_f32 v30, v30
    v_cvt_pk_bf16_f32 v44, v28, v29
    v_exp_f32 v31, v31
    v_mfma_f32_32x32x8_bf16 v[12:27], v[72:73], v[88:89], v[12:27]
    v_cvt_pk_bf16_f32 v45, v30, v31
    ds_read_b64 v[72:73], v10 offset:12800
    v_exp_f32 v32, v32
    v_exp_f32 v33, v33
    v_exp_f32 v34, v34
    v_cvt_pk_bf16_f32 v46, v32, v33
    v_exp_f32 v35, v35
    s_waitcnt lgkmcnt(2)
    v_cvt_pk_bf16_f32 v47, v34, v35
    v_mfma_f32_32x32x16_bf16 v[52:67], v[80:83], v[48:51], v[52:67]
    v_exp_f32 v36, v36
    v_exp_f32 v37, v37
    v_exp_f32 v38, v38
    v_cvt_pk_bf16_f32 v48, v36, v37
    v_exp_f32 v39, v39
    s_setprio 0
    v_mfma_f32_32x32x16_bf16 v[52:67], v[76:79], v[44:47], v[52:67]
    v_cvt_pk_bf16_f32 v49, v38, v39
    s_mov_b64 exec, s[58:59]
    ds_read_b128 v[80:83], v11 offset:8320
    ds_read_b128 v[76:79], v11 offset:10240
    s_mov_b64 exec, -1
    v_exp_f32 v40, v40
    v_exp_f32 v41, v41
    v_exp_f32 v42, v42
    v_cvt_pk_bf16_f32 v50, v40, v41
    v_exp_f32 v43, v43
    s_setprio 3
    s_waitcnt lgkmcnt(2)
    v_cvt_pk_bf16_f32 v51, v42, v43
    v_mfma_f32_32x32x16_bf16 v[28:43], v[68:71], v[84:87], 0
    ds_read_b128 v[68:71], v9 offset:15360
    v_exp_f32 v12, v12
    v_exp_f32 v13, v13
    v_exp_f32 v14, v14
    v_cvt_pk_bf16_f32 v44, v12, v13
    v_exp_f32 v15, v15
    v_mfma_f32_32x32x8_bf16 v[28:43], v[72:73], v[88:89], v[28:43]
    v_cvt_pk_bf16_f32 v45, v14, v15
    ds_read_b64 v[72:73], v10 offset:15360
    v_exp_f32 v16, v16
    v_exp_f32 v17, v17
    v_exp_f32 v18, v18
    v_cvt_pk_bf16_f32 v46, v16, v17
    v_exp_f32 v19, v19
    s_waitcnt lgkmcnt(2)
    v_cvt_pk_bf16_f32 v47, v18, v19
    v_mfma_f32_32x32x16_bf16 v[52:67], v[80:83], v[48:51], v[52:67]
    v_exp_f32 v20, v20
    v_exp_f32 v21, v21
    v_exp_f32 v22, v22
    v_cvt_pk_bf16_f32 v48, v20, v21
    v_exp_f32 v23, v23
    s_setprio 0
    v_mfma_f32_32x32x16_bf16 v[52:67], v[76:79], v[44:47], v[52:67]
    v_cvt_pk_bf16_f32 v49, v22, v23
    s_mov_b64 exec, s[58:59]
    ds_read_b128 v[80:83], v11 offset:10880
    ds_read_b128 v[76:79], v11 offset:12800
    s_mov_b64 exec, -1
    v_exp_f32 v24, v24
    v_exp_f32 v25, v25
    v_exp_f32 v26, v26
    v_cvt_pk_bf16_f32 v50, v24, v25
    v_exp_f32 v27, v27
    s_setprio 3
    s_waitcnt lgkmcnt(2)
    v_cvt_pk_bf16_f32 v51, v26, v27
    v_mfma_f32_32x32x16_bf16 v[12:27], v[68:71], v[84:87], 0
    ds_read_b128 v[68:71], v9 offset:17920
    v_exp_f32 v28, v28
    v_exp_f32 v29, v29
    v_exp_f32 v30, v30
    v_cvt_pk_bf16_f32 v44, v28, v29
    v_exp_f32 v31, v31
    v_mfma_f32_32x32x8_bf16 v[12:27], v[72:73], v[88:89], v[12:27]
    v_cvt_pk_bf16_f32 v45, v30, v31
    ds_read_b64 v[72:73], v10 offset:17920
    v_exp_f32 v32, v32
    v_exp_f32 v33, v33
    v_exp_f32 v34, v34
    v_cvt_pk_bf16_f32 v46, v32, v33
    v_exp_f32 v35, v35
    s_waitcnt lgkmcnt(2)
    v_cvt_pk_bf16_f32 v47, v34, v35
    v_mfma_f32_32x32x16_bf16 v[52:67], v[80:83], v[48:51], v[52:67]
    v_exp_f32 v36, v36
    v_exp_f32 v37, v37
    v_exp_f32 v38, v38
    v_cvt_pk_bf16_f32 v48, v36, v37
    v_exp_f32 v39, v39
    s_setprio 0
    v_mfma_f32_32x32x16_bf16 v[52:67], v[76:79], v[44:47], v[52:67]
    v_cvt_pk_bf16_f32 v49, v38, v39
    s_mov_b64 exec, s[58:59]
    ds_read_b128 v[80:83], v11 offset:13440
    ds_read_b128 v[76:79], v11 offset:15360
    s_mov_b64 exec, -1
    v_exp_f32 v40, v40
    v_exp_f32 v41, v41
    v_exp_f32 v42, v42
    v_cvt_pk_bf16_f32 v50, v40, v41
    v_exp_f32 v43, v43
    s_setprio 3
    s_waitcnt lgkmcnt(2)
    v_cvt_pk_bf16_f32 v51, v42, v43
    v_mfma_f32_32x32x16_bf16 v[28:43], v[68:71], v[84:87], 0
    ds_read_b128 v[68:71], v9 offset:20480
    v_exp_f32 v12, v12
    v_exp_f32 v13, v13
    v_exp_f32 v14, v14
    v_cvt_pk_bf16_f32 v44, v12, v13
    v_exp_f32 v15, v15
    v_mfma_f32_32x32x8_bf16 v[28:43], v[72:73], v[88:89], v[28:43]
    v_cvt_pk_bf16_f32 v45, v14, v15
    ds_read_b64 v[72:73], v10 offset:20480
    v_exp_f32 v16, v16
    v_exp_f32 v17, v17
    v_exp_f32 v18, v18
    v_cvt_pk_bf16_f32 v46, v16, v17
    v_exp_f32 v19, v19
    s_waitcnt lgkmcnt(2)
    v_cvt_pk_bf16_f32 v47, v18, v19
    v_mfma_f32_32x32x16_bf16 v[52:67], v[80:83], v[48:51], v[52:67]
    v_exp_f32 v20, v20
    v_exp_f32 v21, v21
    v_exp_f32 v22, v22
    v_cvt_pk_bf16_f32 v48, v20, v21
    v_exp_f32 v23, v23
    s_setprio 0
    v_mfma_f32_32x32x16_bf16 v[52:67], v[76:79], v[44:47], v[52:67]
    v_cvt_pk_bf16_f32 v49, v22, v23
    s_mov_b64 exec, s[58:59]
    ds_read_b128 v[80:83], v11 offset:16000
    ds_read_b128 v[76:79], v11 offset:17920
    s_mov_b64 exec, -1
    v_exp_f32 v24, v24
    v_exp_f32 v25, v25
    v_exp_f32 v26, v26
    v_cvt_pk_bf16_f32 v50, v24, v25
    v_exp_f32 v27, v27
    s_setprio 3
    s_waitcnt lgkmcnt(2)
    v_cvt_pk_bf16_f32 v51, v26, v27
    v_mfma_f32_32x32x16_bf16 v[12:27], v[68:71], v[84:87], 0
    ds_read_b128 v[68:71], v9 offset:23040
    v_exp_f32 v28, v28
    v_exp_f32 v29, v29
    v_exp_f32 v30, v30
    v_cvt_pk_bf16_f32 v44, v28, v29
    v_exp_f32 v31, v31
    v_mfma_f32_32x32x8_bf16 v[12:27], v[72:73], v[88:89], v[12:27]
    v_cvt_pk_bf16_f32 v45, v30, v31
    ds_read_b64 v[72:73], v10 offset:23040
    v_exp_f32 v32, v32
    v_exp_f32 v33, v33
    v_exp_f32 v34, v34
    v_cvt_pk_bf16_f32 v46, v32, v33
    v_exp_f32 v35, v35
    s_waitcnt lgkmcnt(2)
    v_cvt_pk_bf16_f32 v47, v34, v35
    v_mfma_f32_32x32x16_bf16 v[52:67], v[80:83], v[48:51], v[52:67]
    v_exp_f32 v36, v36
    v_exp_f32 v37, v37
    v_exp_f32 v38, v38
    v_cvt_pk_bf16_f32 v48, v36, v37
    v_exp_f32 v39, v39
    s_setprio 0
    v_mfma_f32_32x32x16_bf16 v[52:67], v[76:79], v[44:47], v[52:67]
    v_cvt_pk_bf16_f32 v49, v38, v39
    s_mov_b64 exec, s[58:59]
    ds_read_b128 v[80:83], v11 offset:18560
    ds_read_b128 v[76:79], v11 offset:20480
    s_mov_b64 exec, -1
    v_exp_f32 v40, v40
    v_exp_f32 v41, v41
    v_exp_f32 v42, v42
    v_cvt_pk_bf16_f32 v50, v40, v41
    v_exp_f32 v43, v43
    s_cmp_eq_u32 s46, 0
    s_cbranch_scc1 K2_BARA
    s_cmp_lg_u32 s46, 3
    s_cbranch_scc1 K2_NOBARA
    s_waitcnt lgkmcnt(0)
K2_BARA:
    s_barrier
K2_NOBARA:
    s_setprio 3
    s_waitcnt lgkmcnt(2)
    v_cvt_pk_bf16_f32 v51, v42, v43
    v_mfma_f32_32x32x16_bf16 v[28:43], v[68:71], v[84:87], 0
    ds_read_b128 v[68:71], v9 offset:25600
    v_exp_f32 v12, v12
    v_exp_f32 v13, v13
    v_exp_f32 v14, v14
    v_cvt_pk_bf16_f32 v44, v12, v13
    v_exp_f32 v15, v15
    v_mfma_f32_32x32x8_bf16 v[28:43], v[72:73], v[88:89], v[28:43]
    v_cvt_pk_bf16_f32 v45, v14, v15
    ds_read_b64 v[72:73], v10 offset:25600
    v_exp_f32 v16, v16
    v_exp_f32 v17, v17
    v_exp_f32 v18, v18
    v_cvt_pk_bf16_f32 v46, v16, v17
    v_exp_f32 v19, v19
    s_waitcnt lgkmcnt(2)
    v_cvt_pk_bf16_f32 v47, v18, v19
    v_mfma_f32_32x32x16_bf16 v[52:67], v[80:83], v[48:51], v[52:67]
    v_exp_f32 v20, v20
    v_exp_f32 v21, v21
    v_exp_f32 v22, v22
    v_cvt_pk_bf16_f32 v48, v20, v21
    v_exp_f32 v23, v23
    s_setprio 0
    v_mfma_f32_32x32x16_bf16 v[52:67], v[76:79], v[44:47], v[52:67]
    v_cvt_pk_bf16_f32 v49, v22, v23
    s_mov_b64 exec, s[58:59]
    ds_read_b128 v[80:83], v11 offset:21120
    ds_read_b128 v[76:79], v11 offset:23040
    s_mov_b64 exec, -1
    v_exp_f32 v24, v24
    v_exp_f32 v25, v25
    v_exp_f32 v26, v26
    v_cvt_pk_bf16_f32 v50, v24, v25
    v_exp_f32 v27, v27
    s_setprio 3
    s_waitcnt lgkmcnt(2)
    v_cvt_pk_bf16_f32 v51, v26, v27
    v_mfma_f32_32x32x16_bf16 v[12:27], v[68:71], v[84:87], 0
    ds_read_b128 v[68:71], v9 offset:28160
    v_exp_f32 v28, v28
    v_exp_f32 v29, v29
    v_exp_f32 v30, v30
    v_cvt_pk_bf16_f32 v44, v28, v29
    v_exp_f32 v31, v31
    v_mfma_f32_32x32x8_bf16 v[12:27], v[72:73], v[88:89], v[12:27]
    v_cvt_pk_bf16_f32 v45, v30, v31
    ds_read_b64 v[72:73], v10 offset:28160
    v_exp_f32 v32, v32
    v_exp_f32 v33, v33
    v_exp_f32 v34, v34
    v_cvt_pk_bf16_f32 v46, v32, v33
    v_exp_f32 v35, v35
    s_waitcnt lgkmcnt(2)
    v_cvt_pk_bf16_f32 v47, v34, v35
    v_mfma_f32_32x32x16_bf16 v[52:67], v[80:83], v[48:51], v[52:67]
    v_exp_f32 v36, v36
    v_exp_f32 v37, v37
    v_exp_f32 v38, v38
    v_cvt_pk_bf16_f32 v48, v36, v37
    v_exp_f32 v39, v39
    s_setprio 0
    v_mfma_f32_32x32x16_bf16 v[52:67], v[76:79], v[44:47], v[52:67]
    v_cvt_pk_bf16_f32 v49, v38, v39
    s_mov_b64 exec, s[58:59]
    ds_read_b128 v[80:83], v11 offset:23680
    ds_read_b128 v[76:79], v11 offset:25600
    s_mov_b64 exec, -1
    v_exp_f32 v40, v40
    v_exp_f32 v41, v41
    v_exp_f32 v42, v42
    v_cvt_pk_bf16_f32 v50, v40, v41
    v_exp_f32 v43, v43
    s_setprio 3
    s_waitcnt lgkmcnt(2)
    v_cvt_pk_bf16_f32 v51, v42, v43
    v_mfma_f32_32x32x16_bf16 v[28:43], v[68:71], v[84:87], 0
    ds_read_b128 v[68:71], v9 offset:30720
    v_exp_f32 v12, v12
    v_exp_f32 v13, v13
    v_exp_f32 v14, v14
    v_cvt_pk_bf16_f32 v44, v12, v13
    v_exp_f32 v15, v15
    v_mfma_f32_32x32x8_bf16 v[28:43], v[72:73], v[88:89], v[28:43]
    v_cvt_pk_bf16_f32 v45, v14, v15
    ds_read_b64 v[72:73], v10 offset:30720
    v_exp_f32 v16, v16
    v_exp_f32 v17, v17
    v_exp_f32 v18, v18
    v_cvt_pk_bf16_f32 v46, v16, v17
    v_exp_f32 v19, v19
    s_waitcnt lgkmcnt(2)
    v_cvt_pk_bf16_f32 v47, v18, v19
    v_mfma_f32_32x32x16_bf16 v[52:67], v[80:83], v[48:51], v[52:67]
    v_exp_f32 v20, v20
    v_exp_f32 v21, v21
    v_exp_f32 v22, v22
    v_cvt_pk_bf16_f32 v48, v20, v21
    v_exp_f32 v23, v23
    s_setprio 0
    v_mfma_f32_32x32x16_bf16 v[52:67], v[76:79], v[44:47], v[52:67]
    v_cvt_pk_bf16_f32 v49, v22, v23
    s_mov_b64 exec, s[58:59]
    ds_read_b128 v[80:83], v11 offset:26240
    ds_read_b128 v[76:79], v11 offset:28160
    s_mov_b64 exec, -1
    v_exp_f32 v24, v24
    v_exp_f32 v25, v25
    v_exp_f32 v26, v26
    v_cvt_pk_bf16_f32 v50, v24, v25
    v_exp_f32 v27, v27
    s_setprio 3
    s_waitcnt lgkmcnt(2)
    v_cvt_pk_bf16_f32 v51, v26, v27
    v_mfma_f32_32x32x16_bf16 v[12:27], v[68:71], v[84:87], 0
    ds_read_b128 v[68:71], v9 offset:33280
    v_exp_f32 v28, v28
    v_exp_f32 v29, v29
    v_exp_f32 v30, v30
    v_cvt_pk_bf16_f32 v44, v28, v29
    v_exp_f32 v31, v31
    v_mfma_f32_32x32x8_bf16 v[12:27], v[72:73], v[88:89], v[12:27]
    v_cvt_pk_bf16_f32 v45, v30, v31
    ds_read_b64 v[72:73], v10 offset:33280
    v_exp_f32 v32, v32
    v_exp_f32 v33, v33
    v_exp_f32 v34, v34
    v_cvt_pk_bf16_f32 v46, v32, v33
    v_exp_f32 v35, v35
    s_waitcnt lgkmcnt(2)
    v_cvt_pk_bf16_f32 v47, v34, v35
    v_mfma_f32_32x32x16_bf16 v[52:67], v[80:83], v[48:51], v[52:67]
    v_exp_f32 v36, v36
    v_exp_f32 v37, v37
    v_exp_f32 v38, v38
    v_cvt_pk_bf16_f32 v48, v36, v37
    v_exp_f32 v39, v39
    s_setprio 0
    v_mfma_f32_32x32x16_bf16 v[52:67], v[76:79], v[44:47], v[52:67]
    v_cvt_pk_bf16_f32 v49, v38, v39
    s_mov_b64 exec, s[58:59]
    ds_read_b128 v[80:83], v11 offset:28800
    ds_read_b128 v[76:79], v11 offset:30720
    s_mov_b64 exec, -1
    v_exp_f32 v40, v40
    v_exp_f32 v41, v41
    v_exp_f32 v42, v42
    v_cvt_pk_bf16_f32 v50, v40, v41
    v_exp_f32 v43, v43
    s_setprio 3
    s_waitcnt lgkmcnt(2)
    v_cvt_pk_bf16_f32 v51, v42, v43
    v_mfma_f32_32x32x16_bf16 v[28:43], v[68:71], v[84:87], 0
    ds_read_b128 v[68:71], v9 offset:35840
    v_exp_f32 v12, v12
    v_exp_f32 v13, v13
    v_exp_f32 v14, v14
    v_cvt_pk_bf16_f32 v44, v12, v13
    v_exp_f32 v15, v15
    v_mfma_f32_32x32x8_bf16 v[28:43], v[72:73], v[88:89], v[28:43]
    v_cvt_pk_bf16_f32 v45, v14, v15
    ds_read_b64 v[72:73], v10 offset:35840
    v_exp_f32 v16, v16
    v_exp_f32 v17, v17
    v_exp_f32 v18, v18
    v_cvt_pk_bf16_f32 v46, v16, v17
    v_exp_f32 v19, v19
    s_waitcnt lgkmcnt(2)
    v_cvt_pk_bf16_f32 v47, v18, v19
    v_mfma_f32_32x32x16_bf16 v[52:67], v[80:83], v[48:51], v[52:67]
    v_exp_f32 v20, v20
    v_exp_f32 v21, v21
    v_exp_f32 v22, v22
    v_cvt_pk_bf16_f32 v48, v20, v21
    v_exp_f32 v23, v23
    s_setprio 0
    v_mfma_f32_32x32x16_bf16 v[52:67], v[76:79], v[44:47], v[52:67]
    v_cvt_pk_bf16_f32 v49, v22, v23
    s_mov_b64 exec, s[58:59]
    ds_read_b128 v[80:83], v11 offset:31360
    ds_read_b128 v[76:79], v11 offset:33280
    s_mov_b64 exec, -1
    v_exp_f32 v24, v24
    v_exp_f32 v25, v25
    v_exp_f32 v26, v26
    v_cvt_pk_bf16_f32 v50, v24, v25
    v_exp_f32 v27, v27
    s_setprio 3
    s_waitcnt lgkmcnt(2)
    v_cvt_pk_bf16_f32 v51, v26, v27
    v_mfma_f32_32x32x16_bf16 v[12:27], v[68:71], v[84:87], 0
    ds_read_b128 v[68:71], v9 offset:38400
    v_exp_f32 v28, v28
    v_exp_f32 v29, v29
    v_exp_f32 v30, v30
    v_cvt_pk_bf16_f32 v44, v28, v29
    v_exp_f32 v31, v31
    v_mfma_f32_32x32x8_bf16 v[12:27], v[72:73], v[88:89], v[12:27]
    v_cvt_pk_bf16_f32 v45, v30, v31
    ds_read_b64 v[72:73], v10 offset:38400
    v_exp_f32 v32, v32
    v_exp_f32 v33, v33
    v_exp_f32 v34, v34
    v_cvt_pk_bf16_f32 v46, v32, v33
    v_exp_f32 v35, v35
    s_waitcnt lgkmcnt(2)
    v_cvt_pk_bf16_f32 v47, v34, v35
    v_mfma_f32_32x32x16_bf16 v[52:67], v[80:83], v[48:51], v[52:67]
    v_exp_f32 v36, v36
    v_exp_f32 v37, v37
    v_exp_f32 v38, v38
    v_cvt_pk_bf16_f32 v48, v36, v37
    v_exp_f32 v39, v39
    s_setprio 0
    v_mfma_f32_32x32x16_bf16 v[52:67], v[76:79], v[44:47], v[52:67]
    v_cvt_pk_bf16_f32 v49, v38, v39
    s_mov_b64 exec, s[58:59]
    ds_read_b128 v[80:83], v11 offset:33920
    ds_read_b128 v[76:79], v11 offset:35840
    s_mov_b64 exec, -1
    v_exp_f32 v40, v40
    v_exp_f32 v41, v41
    v_exp_f32 v42, v42
    v_cvt_pk_bf16_f32 v50, v40, v41
    v_exp_f32 v43, v43
    s_setprio 3
    s_waitcnt lgkmcnt(2)
    v_cvt_pk_bf16_f32 v51, v42, v43
    v_mfma_f32_32x32x16_bf16 v[28:43], v[68:71], v[84:87], 0
    ds_read_b128 v[68:71], v9 offset:40960
    v_exp_f32 v12, v12
    v_exp_f32 v13, v13
    v_exp_f32 v14, v14
    v_cvt_pk_bf16_f32 v44, v12, v13
    v_exp_f32 v15, v15
    v_mfma_f32_32x32x8_bf16 v[28:43], v[72:73], v[88:89], v[28:43]
    v_cvt_pk_bf16_f32 v45, v14, v15
    ds_read_b64 v[72:73], v10 offset:40960
    v_exp_f32 v16, v16
    v_exp_f32 v17, v17
    v_exp_f32 v18, v18
    v_cvt_pk_bf16_f32 v46, v16, v17
    v_exp_f32 v19, v19
    s_waitcnt lgkmcnt(2)
    v_cvt_pk_bf16_f32 v47, v18, v19
    v_mfma_f32_32x32x16_bf16 v[52:67], v[80:83], v[48:51], v[52:67]
    v_exp_f32 v20, v20
    v_exp_f32 v21, v21
    v_exp_f32 v22, v22
    v_cvt_pk_bf16_f32 v48, v20, v21
    v_exp_f32 v23, v23
    s_setprio 0
    v_mfma_f32_32x32x16_bf16 v[52:67], v[76:79], v[44:47], v[52:67]
    v_cvt_pk_bf16_f32 v49, v22, v23
    s_mov_b64 exec, s[58:59]
    ds_read_b128 v[80:83], v11 offset:36480
    ds_read_b128 v[76:79], v11 offset:38400
    s_mov_b64 exec, -1
    v_exp_f32 v24, v24
    v_exp_f32 v25, v25
    v_exp_f32 v26, v26
    v_cvt_pk_bf16_f32 v50, v24, v25
    v_exp_f32 v27, v27
    s_setprio 3
    s_waitcnt lgkmcnt(2)
    v_cvt_pk_bf16_f32 v51, v26, v27
    v_mfma_f32_32x32x16_bf16 v[12:27], v[68:71], v[84:87], 0
    ds_read_b128 v[68:71], v9 offset:43520
    v_exp_f32 v28, v28
    v_exp_f32 v29, v29
    v_exp_f32 v30, v30
    v_cvt_pk_bf16_f32 v44, v28, v29
    v_exp_f32 v31, v31
    v_mfma_f32_32x32x8_bf16 v[12:27], v[72:73], v[88:89], v[12:27]
    v_cvt_pk_bf16_f32 v45, v30, v31
    ds_read_b64 v[72:73], v10 offset:43520
    v_exp_f32 v32, v32
    v_exp_f32 v33, v33
    v_exp_f32 v34, v34
    v_cvt_pk_bf16_f32 v46, v32, v33
    v_exp_f32 v35, v35
    s_waitcnt lgkmcnt(2)
    v_cvt_pk_bf16_f32 v47, v34, v35
    v_mfma_f32_32x32x16_bf16 v[52:67], v[80:83], v[48:51], v[52:67]
    v_exp_f32 v36, v36
    v_exp_f32 v37, v37
    v_exp_f32 v38, v38
    v_cvt_pk_bf16_f32 v48, v36, v37
    v_exp_f32 v39, v39
    s_setprio 0
    v_mfma_f32_32x32x16_bf16 v[52:67], v[76:79], v[44:47], v[52:67]
    v_cvt_pk_bf16_f32 v49, v38, v39
    s_mov_b64 exec, s[58:59]
    ds_read_b128 v[80:83], v11 offset:39040
    ds_read_b128 v[76:79], v11 offset:40960
    s_mov_b64 exec, -1
    v_exp_f32 v40, v40
    v_exp_f32 v41, v41
    v_exp_f32 v42, v42
    v_cvt_pk_bf16_f32 v50, v40, v41
    v_exp_f32 v43, v43
    v_add_u32 v9, 40960, v9
    v_cvt_pk_bf16_f32 v51, v42, v43
    v_add_u32 v10, 40960, v10
    v_add_u32 v11, 40960, v11
    s_add_u32 s46, s46, 1
    s_cmp_lt_u32 s46, 4
    s_cbranch_scc1 K2_LOOPA
    s_branch K2_LOOPX
K2_LOOPB:
    s_setprio 2
    s_waitcnt lgkmcnt(2)
    v_mfma_f32_32x32x16_bf16 v[28:43], v[68:71], v[84:87], 0
    ds_read_b128 v[68:71], v9 offset:5120
    v_exp_f32 v12, v12
    v_exp_f32 v13, v13
    v_exp_f32 v14, v14
    v_cvt_pk_bf16_f32 v44, v12, v13
    v_exp_f32 v15, v15
    v_mfma_f32_32x32x8_bf16 v[28:43], v[72:73], v[88:89], v[28:43]
    v_cvt_pk_bf16_f32 v45, v14, v15
    ds_read_b64 v[72:73], v10 offset:5120
    v_exp_f32 v16, v16
    v_exp_f32 v17, v17
    v_exp_f32 v18, v18
    v_cvt_pk_bf16_f32 v46, v16, v17
    v_exp_f32 v19, v19
    s_waitcnt lgkmcnt(2)
    v_cvt_pk_bf16_f32 v47, v18, v19
    v_mfma_f32_32x32x16_bf16 v[52:67], v[80:83], v[48:51], v[52:67]
    v_exp_f32 v20, v20
    v_exp_f32 v21, v21
    v_exp_f32 v22, v22
    v_cvt_pk_bf16_f32 v48, v20, v21
    v_exp_f32 v23, v23
    s_setprio 1
    v_mfma_f32_32x32x16_bf16 v[52:67], v[76:79], v[44:47], v[52:67]
    v_cvt_pk_bf16_f32 v49, v22, v23
    s_mov_b64 exec, s[58:59]
    ds_read_b128 v[80:83], v11 offset:640
    ds_read_b128 v[76:79], v11 offset:2560
    s_mov_b64 exec, -1
    v_exp_f32 v24, v24
    v_exp_f32 v25, v25
    v_exp_f32 v26, v26
    v_cvt_pk_bf16_f32 v50, v24, v25
    v_exp_f32 v27, v27
    s_setprio 2
    s_waitcnt lgkmcnt(2)
    v_cvt_pk_bf16_f32 v51, v26, v27
    v_mfma_f32_32x32x16_bf16 v[12:27], v[68:71], v[84:87], 0
    ds_read_b128 v[68:71], v9 offset:7680
    v_exp_f32 v28, v28
    v_exp_f32 v29, v29
    v_exp_f32 v30, v30
    v_cvt_pk_bf16_f32 v44, v28, v29
    v_exp_f32 v31, v31
    v_mfma_f32_32x32x8_bf16 v[12:27], v[72:73], v[88:89], v[12:27]
    v_cvt_pk_bf16_f32 v45, v30, v31
    ds_read_b64 v[72:73], v10 offset:7680
    v_exp_f32 v32, v32
    v_exp_f32 v33, v33
    v_exp_f32 v34, v34
    v_cvt_pk_bf16_f32 v46, v32, v33
    v_exp_f32 v35, v35
    s_waitcnt lgkmcnt(2)
    v_cvt_pk_bf16_f32 v47, v34, v35
    v_mfma_f32_32x32x16_bf16 v[52:67], v[80:83], v[48:51], v[52:67]
    v_exp_f32 v36, v36
    v_exp_f32 v37, v37
    v_exp_f32 v38, v38
    v_cvt_pk_bf16_f32 v48, v36, v37
    v_exp_f32 v39, v39
    s_setprio 1
    v_mfma_f32_32x32x16_bf16 v[52:67], v[76:79], v[44:47], v[52:67]
    v_cvt_pk_bf16_f32 v49, v38, v39
    s_mov_b64 exec, s[58:59]
    ds_read_b128 v[80:83], v11 offset:3200
    ds_read_b128 v[76:79], v11 offset:5120
    s_mov_b64 exec, -1
    v_exp_f32 v40, v40
    v_exp_f32 v41, v41
    v_exp_f32 v42, v42
    v_cvt_pk_bf16_f32 v50, v40, v41
    v_exp_f32 v43, v43
    s_setprio 2
    s_waitcnt lgkmcnt(2)
    v_cvt_pk_bf16_f32 v51, v42, v43
    v_mfma_f32_32x32x16_bf16 v[28:43], v[68:71], v[84:87], 0
    ds_read_b128 v[68:71], v9 offset:10240
    v_exp_f32 v12, v12
    v_exp_f32 v13, v13
    v_exp_f32 v14, v14
    v_cvt_pk_bf16_f32 v44, v12, v13
    v_exp_f32 v15, v15
    v_mfma_f32_32x32x8_bf16 v[28:43], v[72:73], v[88:89], v[28:43]
    v_cvt_pk_bf16_f32 v45, v14, v15
    ds_read_b64 v[72:73], v10 offset:10240
    v_exp_f32 v16, v16
    v_exp_f32 v17, v17
    v_exp_f32 v18, v18
    v_cvt_pk_bf16_f32 v46, v16, v17
    v_exp_f32 v19, v19
    s_waitcnt lgkmcnt(2)
    v_cvt_pk_bf16_f32 v47, v18, v19
    v_mfma_f32_32x32x16_bf16 v[52:67], v[80:83], v[48:51], v[52:67]
    v_exp_f32 v20, v20
    v_exp_f32 v21, v21
    v_exp_f32 v22, v22
    v_cvt_pk_bf16_f32 v48, v20, v21
    v_exp_f32 v23, v23
    s_setprio 1
    v_mfma_f32_32x32x16_bf16 v[52:67], v[76:79], v[44:47], v[52:67]
    v_cvt_pk_bf16_f32 v49, v22, v23
    s_mov_b64 exec, s[58:59]
    ds_read_b128 v[80:83], v11 offset:5760
    ds_read_b128 v[76:79], v11 offset:7680
    s_mov_b64 exec, -1
    v_exp_f32 v24, v24
    v_exp_f32 v25, v25
    v_exp_f32 v26, v26
    v_cvt_pk_bf16_f32 v50, v24, v25
    v_exp_f32 v27, v27
    s_setprio 2
    s_waitcnt lgkmcnt(2)
    v_cvt_pk_bf16_f32 v51, v26, v27
    v_mfma_f32_32x32x16_bf16 v[12:27], v[68:71], v[84:87], 0
    ds_read_b128 v[68:71], v9 offset:12800
    v_exp_f32 v28, v28
    v_exp_f32 v29, v29
    v_exp_f32 v30, v30
    v_cvt_pk_bf16_f32 v44, v28, v29
    v_exp_f32 v31, v31
    v_mfma_f32_32x32x8_bf16 v[12:27], v[72:73], v[88:89], v[12:27]
    v_cvt_pk_bf16_f32 v45, v30, v31
    ds_read_b64 v[72:73], v10 offset:12800
    v_exp_f32 v32, v32
    v_exp_f32 v33, v33
    v_exp_f32 v34, v34
    v_cvt_pk_bf16_f32 v46, v32, v33
    v_exp_f32 v35, v35
    s_waitcnt lgkmcnt(2)
    v_cvt_pk_bf16_f32 v47, v34, v35
    v_mfma_f32_32x32x16_bf16 v[52:67], v[80:83], v[48:51], v[52:67]
    v_exp_f32 v36, v36
    v_exp_f32 v37, v37
    v_exp_f32 v38, v38
    v_cvt_pk_bf16_f32 v48, v36, v37
    v_exp_f32 v39, v39
    s_setprio 1
    v_mfma_f32_32x32x16_bf16 v[52:67], v[76:79], v[44:47], v[52:67]
    v_cvt_pk_bf16_f32 v49, v38, v39
    s_mov_b64 exec, s[58:59]
    ds_read_b128 v[80:83], v11 offset:8320
    ds_read_b128 v[76:79], v11 offset:10240
    s_mov_b64 exec, -1
    v_exp_f32 v40, v40
    v_exp_f32 v41, v41
    v_exp_f32 v42, v42
    v_cvt_pk_bf16_f32 v50, v40, v41
    v_exp_f32 v43, v43
    s_setprio 2
    s_waitcnt lgkmcnt(2)
    v_cvt_pk_bf16_f32 v51, v42, v43
    v_mfma_f32_32x32x16_bf16 v[28:43], v[68:71], v[84:87], 0
    ds_read_b128 v[68:71], v9 offset:15360
    v_exp_f32 v12, v12
    v_exp_f32 v13, v13
    v_exp_f32 v14, v14
    v_cvt_pk_bf16_f32 v44, v12, v13
    v_exp_f32 v15, v15
    v_mfma_f32_32x32x8_bf16 v[28:43], v[72:73], v[88:89], v[28:43]
    v_cvt_pk_bf16_f32 v45, v14, v15
    ds_read_b64 v[72:73], v10 offset:15360
    v_exp_f32 v16, v16
    v_exp_f32 v17, v17
    v_exp_f32 v18, v18
    v_cvt_pk_bf16_f32 v46, v16, v17
    v_exp_f32 v19, v19
    s_waitcnt lgkmcnt(2)
    v_cvt_pk_bf16_f32 v47, v18, v19
    v_mfma_f32_32x32x16_bf16 v[52:67], v[80:83], v[48:51], v[52:67]
    v_exp_f32 v20, v20
    v_exp_f32 v21, v21
    v_exp_f32 v22, v22
    v_cvt_pk_bf16_f32 v48, v20, v21
    v_exp_f32 v23, v23
    s_setprio 1
    v_mfma_f32_32x32x16_bf16 v[52:67], v[76:79], v[44:47], v[52:67]
    v_cvt_pk_bf16_f32 v49, v22, v23
    s_mov_b64 exec, s[58:59]
    ds_read_b128 v[80:83], v11 offset:10880
    ds_read_b128 v[76:79], v11 offset:12800
    s_mov_b64 exec, -1
    v_exp_f32 v24, v24
    v_exp_f32 v25, v25
    v_exp_f32 v26, v26
    v_cvt_pk_bf16_f32 v50, v24, v25
    v_exp_f32 v27, v27
    s_setprio 2
    s_waitcnt lgkmcnt(2)
    v_cvt_pk_bf16_f32 v51, v26, v27
    v_mfma_f32_32x32x16_bf16 v[12:27], v[68:71], v[84:87], 0
    ds_read_b128 v[68:71], v9 offset:17920
    v_exp_f32 v28, v28
    v_exp_f32 v29, v29
    v_exp_f32 v30, v30
    v_cvt_pk_bf16_f32 v44, v28, v29
    v_exp_f32 v31, v31
    v_mfma_f32_32x32x8_bf16 v[12:27], v[72:73], v[88:89], v[12:27]
    v_cvt_pk_bf16_f32 v45, v30, v31
    ds_read_b64 v[72:73], v10 offset:17920
    v_exp_f32 v32, v32
    v_exp_f32 v33, v33
    v_exp_f32 v34, v34
    v_cvt_pk_bf16_f32 v46, v32, v33
    v_exp_f32 v35, v35
    s_waitcnt lgkmcnt(2)
    v_cvt_pk_bf16_f32 v47, v34, v35
    v_mfma_f32_32x32x16_bf16 v[52:67], v[80:83], v[48:51], v[52:67]
    v_exp_f32 v36, v36
    v_exp_f32 v37, v37
    v_exp_f32 v38, v38
    v_cvt_pk_bf16_f32 v48, v36, v37
    v_exp_f32 v39, v39
    s_setprio 1
    v_mfma_f32_32x32x16_bf16 v[52:67], v[76:79], v[44:47], v[52:67]
    v_cvt_pk_bf16_f32 v49, v38, v39
    s_mov_b64 exec, s[58:59]
    ds_read_b128 v[80:83], v11 offset:13440
    ds_read_b128 v[76:79], v11 offset:15360
    s_mov_b64 exec, -1
    v_exp_f32 v40, v40
    v_exp_f32 v41, v41
    v_exp_f32 v42, v42
    v_cvt_pk_bf16_f32 v50, v40, v41
    v_exp_f32 v43, v43
    s_setprio 2
    s_waitcnt lgkmcnt(2)
    v_cvt_pk_bf16_f32 v51, v42, v43
    v_mfma_f32_32x32x16_bf16 v[28:43], v[68:71], v[84:87], 0
    ds_read_b128 v[68:71], v9 offset:20480
    v_exp_f32 v12, v12
    v_exp_f32 v13, v13
    v_exp_f32 v14, v14
    v_cvt_pk_bf16_f32 v44, v12, v13
    v_exp_f32 v15, v15
    v_mfma_f32_32x32x8_bf16 v[28:43], v[72:73], v[88:89], v[28:43]
    v_cvt_pk_bf16_f32 v45, v14, v15
    ds_read_b64 v[72:73], v10 offset:20480
    v_exp_f32 v16, v16
    v_exp_f32 v17, v17
    v_exp_f32 v18, v18
    v_cvt_pk_bf16_f32 v46, v16, v17
    v_exp_f32 v19, v19
    s_waitcnt lgkmcnt(2)
    v_cvt_pk_bf16_f32 v47, v18, v19
    v_mfma_f32_32x32x16_bf16 v[52:67], v[80:83], v[48:51], v[52:67]
    v_exp_f32 v20, v20
    v_exp_f32 v21, v21
    v_exp_f32 v22, v22
    v_cvt_pk_bf16_f32 v48, v20, v21
    v_exp_f32 v23, v23
    s_setprio 1
    v_mfma_f32_32x32x16_bf16 v[52:67], v[76:79], v[44:47], v[52:67]
    v_cvt_pk_bf16_f32 v49, v22, v23
    s_mov_b64 exec, s[58:59]
    ds_read_b128 v[80:83], v11 offset:16000
    ds_read_b128 v[76:79], v11 offset:17920
    s_mov_b64 exec, -1
    v_exp_f32 v24, v24
    v_exp_f32 v25, v25
    v_exp_f32 v26, v26
    v_cvt_pk_bf16_f32 v50, v24, v25
    v_exp_f32 v27, v27
    s_setprio 2
    s_waitcnt lgkmcnt(2)
    v_cvt_pk_bf16_f32 v51, v26, v27
    v_mfma_f32_32x32x16_bf16 v[12:27], v[68:71], v[84:87], 0
    ds_read_b128 v[68:71], v9 offset:23040
    v_exp_f32 v28, v28
    v_exp_f32 v29, v29
    v_exp_f32 v30, v30
    v_cvt_pk_bf16_f32 v44, v28, v29
    v_exp_f32 v31, v31
    v_mfma_f32_32x32x8_bf16 v[12:27], v[72:73], v[88:89], v[12:27]
    v_cvt_pk_bf16_f32 v45, v30, v31
    ds_read_b64 v[72:73], v10 offset:23040
    v_exp_f32 v32, v32
    v_exp_f32 v33, v33
    v_exp_f32 v34, v34
    v_cvt_pk_bf16_f32 v46, v32, v33
    v_exp_f32 v35, v35
    s_waitcnt lgkmcnt(2)
    v_cvt_pk_bf16_f32 v47, v34, v35
    v_mfma_f32_32x32x16_bf16 v[52:67], v[80:83], v[48:51], v[52:67]
    v_exp_f32 v36, v36
    v_exp_f32 v37, v37
    v_exp_f32 v38, v38
    v_cvt_pk_bf16_f32 v48, v36, v37
    v_exp_f32 v39, v39
    s_setprio 1
    v_mfma_f32_32x32x16_bf16 v[52:67], v[76:79], v[44:47], v[52:67]
    v_cvt_pk_bf16_f32 v49, v38, v39
    s_mov_b64 exec, s[58:59]
    ds_read_b128 v[80:83], v11 offset:18560
    ds_read_b128 v[76:79], v11 offset:20480
    s_mov_b64 exec, -1
    v_exp_f32 v40, v40
    v_exp_f32 v41, v41
    v_exp_f32 v42, v42
    v_cvt_pk_bf16_f32 v50, v40, v41
    v_exp_f32 v43, v43
    s_cmp_eq_u32 s46, 0
    s_cbranch_scc1 K2_BARB
    s_cmp_lg_u32 s46, 3
    s_cbranch_scc1 K2_NOBARB
    s_waitcnt lgkmcnt(0)
K2_BARB:
    s_barrier
K2_NOBARB:
    s_setprio 2
    s_waitcnt lgkmcnt(2)
    v_cvt_pk_bf16_f32 v51, v42, v43
    v_mfma_f32_32x32x16_bf16 v[28:43], v[68:71], v[84:87], 0
    ds_read_b128 v[68:71], v9 offset:25600
    v_exp_f32 v12, v12
    v_exp_f32 v13, v13
    v_exp_f32 v14, v14
    v_cvt_pk_bf16_f32 v44, v12, v13
    v_exp_f32 v15, v15
    v_mfma_f32_32x32x8_bf16 v[28:43], v[72:73], v[88:89], v[28:43]
    v_cvt_pk_bf16_f32 v45, v14, v15
    ds_read_b64 v[72:73], v10 offset:25600
    v_exp_f32 v16, v16
    v_exp_f32 v17, v17
    v_exp_f32 v18, v18
    v_cvt_pk_bf16_f32 v46, v16, v17
    v_exp_f32 v19, v19
    s_waitcnt lgkmcnt(2)
    v_cvt_pk_bf16_f32 v47, v18, v19
    v_mfma_f32_32x32x16_bf16 v[52:67], v[80:83], v[48:51], v[52:67]
    v_exp_f32 v20, v20
    v_exp_f32 v21, v21
    v_exp_f32 v22, v22
    v_cvt_pk_bf16_f32 v48, v20, v21
    v_exp_f32 v23, v23
    s_setprio 1
    v_mfma_f32_32x32x16_bf16 v[52:67], v[76:79], v[44:47], v[52:67]
    v_cvt_pk_bf16_f32 v49, v22, v23
    s_mov_b64 exec, s[58:59]
    ds_read_b128 v[80:83], v11 offset:21120
    ds_read_b128 v[76:79], v11 offset:23040
    s_mov_b64 exec, -1
    v_exp_f32 v24, v24
    v_exp_f32 v25, v25
    v_exp_f32 v26, v26
    v_cvt_pk_bf16_f32 v50, v24, v25
    v_exp_f32 v27, v27
    s_setprio 2
    s_waitcnt lgkmcnt(2)
    v_cvt_pk_bf16_f32 v51, v26, v27
    v_mfma_f32_32x32x16_bf16 v[12:27], v[68:71], v[84:87], 0
    ds_read_b128 v[68:71], v9 offset:28160
    v_exp_f32 v28, v28
    v_exp_f32 v29, v29
    v_exp_f32 v30, v30
    v_cvt_pk_bf16_f32 v44, v28, v29
    v_exp_f32 v31, v31
    v_mfma_f32_32x32x8_bf16 v[12:27], v[72:73], v[88:89], v[12:27]
    v_cvt_pk_bf16_f32 v45, v30, v31
    ds_read_b64 v[72:73], v10 offset:28160
    v_exp_f32 v32, v32
    v_exp_f32 v33, v33
    v_exp_f32 v34, v34
    v_cvt_pk_bf16_f32 v46, v32, v33
    v_exp_f32 v35, v35
    s_waitcnt lgkmcnt(2)
    v_cvt_pk_bf16_f32 v47, v34, v35
    v_mfma_f32_32x32x16_bf16 v[52:67], v[80:83], v[48:51], v[52:67]
    v_exp_f32 v36, v36
    v_exp_f32 v37, v37
    v_exp_f32 v38, v38
    v_cvt_pk_bf16_f32 v48, v36, v37
    v_exp_f32 v39, v39
    s_setprio 1
    v_mfma_f32_32x32x16_bf16 v[52:67], v[76:79], v[44:47], v[52:67]
    v_cvt_pk_bf16_f32 v49, v38, v39
    s_mov_b64 exec, s[58:59]
    ds_read_b128 v[80:83], v11 offset:23680
    ds_read_b128 v[76:79], v11 offset:25600
    s_mov_b64 exec, -1
    v_exp_f32 v40, v40
    v_exp_f32 v41, v41
    v_exp_f32 v42, v42
    v_cvt_pk_bf16_f32 v50, v40, v41
    v_exp_f32 v43, v43
    s_setprio 2
    s_waitcnt lgkmcnt(2)
    v_cvt_pk_bf16_f32 v51, v42, v43
    v_mfma_f32_32x32x16_bf16 v[28:43], v[68:71], v[84:87], 0
    ds_read_b128 v[68:71], v9 offset:30720
    v_exp_f32 v12, v12
    v_exp_f32 v13, v13
    v_exp_f32 v14, v14
    v_cvt_pk_bf16_f32 v44, v12, v13
    v_exp_f32 v15, v15
    v_mfma_f32_32x32x8_bf16 v[28:43], v[72:73], v[88:89], v[28:43]
    v_cvt_pk_bf16_f32 v45, v14, v15
    ds_read_b64 v[72:73], v10 offset:30720
    v_exp_f32 v16, v16
    v_exp_f32 v17, v17
    v_exp_f32 v18, v18
    v_cvt_pk_bf16_f32 v46, v16, v17
    v_exp_f32 v19, v19
    s_waitcnt lgkmcnt(2)
    v_cvt_pk_bf16_f32 v47, v18, v19
    v_mfma_f32_32x32x16_bf16 v[52:67], v[80:83], v[48:51], v[52:67]
    v_exp_f32 v20, v20
    v_exp_f32 v21, v21
    v_exp_f32 v22, v22
    v_cvt_pk_bf16_f32 v48, v20, v21
    v_exp_f32 v23, v23
    s_setprio 1
    v_mfma_f32_32x32x16_bf16 v[52:67], v[76:79], v[44:47], v[52:67]
    v_cvt_pk_bf16_f32 v49, v22, v23
    s_mov_b64 exec, s[58:59]
    ds_read_b128 v[80:83], v11 offset:26240
    ds_read_b128 v[76:79], v11 offset:28160
    s_mov_b64 exec, -1
    v_exp_f32 v24, v24
    v_exp_f32 v25, v25
    v_exp_f32 v26, v26
    v_cvt_pk_bf16_f32 v50, v24, v25
    v_exp_f32 v27, v27
    s_setprio 2
    s_waitcnt lgkmcnt(2)
    v_cvt_pk_bf16_f32 v51, v26, v27
    v_mfma_f32_32x32x16_bf16 v[12:27], v[68:71], v[84:87], 0
    ds_read_b128 v[68:71], v9 offset:33280
    v_exp_f32 v28, v28
    v_exp_f32 v29, v29
    v_exp_f32 v30, v30
    v_cvt_pk_bf16_f32 v44, v28, v29
    v_exp_f32 v31, v31
    v_mfma_f32_32x32x8_bf16 v[12:27], v[72:73], v[88:89], v[12:27]
    v_cvt_pk_bf16_f32 v45, v30, v31
    ds_read_b64 v[72:73], v10 offset:33280
    v_exp_f32 v32, v32
    v_exp_f32 v33, v33
    v_exp_f32 v34, v34
    v_cvt_pk_bf16_f32 v46, v32, v33
    v_exp_f32 v35, v35
    s_waitcnt lgkmcnt(2)
    v_cvt_pk_bf16_f32 v47, v34, v35
    v_mfma_f32_32x32x16_bf16 v[52:67], v[80:83], v[48:51], v[52:67]
    v_exp_f32 v36, v36
    v_exp_f32 v37, v37
    v_exp_f32 v38, v38
    v_cvt_pk_bf16_f32 v48, v36, v37
    v_exp_f32 v39, v39
    s_setprio 1
    v_mfma_f32_32x32x16_bf16 v[52:67], v[76:79], v[44:47], v[52:67]
    v_cvt_pk_bf16_f32 v49, v38, v39
    s_mov_b64 exec, s[58:59]
    ds_read_b128 v[80:83], v11 offset:28800
    ds_read_b128 v[76:79], v11 offset:30720
    s_mov_b64 exec, -1
    v_exp_f32 v40, v40
    v_exp_f32 v41, v41
    v_exp_f32 v42, v42
    v_cvt_pk_bf16_f32 v50, v40, v41
    v_exp_f32 v43, v43
    s_setprio 2
    s_waitcnt lgkmcnt(2)
    v_cvt_pk_bf16_f32 v51, v42, v43
    v_mfma_f32_32x32x16_bf16 v[28:43], v[68:71], v[84:87], 0
    ds_read_b128 v[68:71], v9 offset:35840
    v_exp_f32 v12, v12
    v_exp_f32 v13, v13
    v_exp_f32 v14, v14
    v_cvt_pk_bf16_f32 v44, v12, v13
    v_exp_f32 v15, v15
    v_mfma_f32_32x32x8_bf16 v[28:43], v[72:73], v[88:89], v[28:43]
    v_cvt_pk_bf16_f32 v45, v14, v15
    ds_read_b64 v[72:73], v10 offset:35840
    v_exp_f32 v16, v16
    v_exp_f32 v17, v17
    v_exp_f32 v18, v18
    v_cvt_pk_bf16_f32 v46, v16, v17
    v_exp_f32 v19, v19
    s_waitcnt lgkmcnt(2)
    v_cvt_pk_bf16_f32 v47, v18, v19
    v_mfma_f32_32x32x16_bf16 v[52:67], v[80:83], v[48:51], v[52:67]
    v_exp_f32 v20, v20
    v_exp_f32 v21, v21
    v_exp_f32 v22, v22
    v_cvt_pk_bf16_f32 v48, v20, v21
    v_exp_f32 v23, v23
    s_setprio 1
    v_mfma_f32_32x32x16_bf16 v[52:67], v[76:79], v[44:47], v[52:67]
    v_cvt_pk_bf16_f32 v49, v22, v23
    s_mov_b64 exec, s[58:59]
    ds_read_b128 v[80:83], v11 offset:31360
    ds_read_b128 v[76:79], v11 offset:33280
    s_mov_b64 exec, -1
    v_exp_f32 v24, v24
    v_exp_f32 v25, v25
    v_exp_f32 v26, v26
    v_cvt_pk_bf16_f32 v50, v24, v25
    v_exp_f32 v27, v27
    s_setprio 2
    s_waitcnt lgkmcnt(2)
    v_cvt_pk_bf16_f32 v51, v26, v27
    v_mfma_f32_32x32x16_bf16 v[12:27], v[68:71], v[84:87], 0
    ds_read_b128 v[68:71], v9 offset:38400
    v_exp_f32 v28, v28
    v_exp_f32 v29, v29
    v_exp_f32 v30, v30
    v_cvt_pk_bf16_f32 v44, v28, v29
    v_exp_f32 v31, v31
    v_mfma_f32_32x32x8_bf16 v[12:27], v[72:73], v[88:89], v[12:27]
    v_cvt_pk_bf16_f32 v45, v30, v31
    ds_read_b64 v[72:73], v10 offset:38400
    v_exp_f32 v32, v32
    v_exp_f32 v33, v33
    v_exp_f32 v34, v34
    v_cvt_pk_bf16_f32 v46, v32, v33
    v_exp_f32 v35, v35
    s_waitcnt lgkmcnt(2)
    v_cvt_pk_bf16_f32 v47, v34, v35
    v_mfma_f32_32x32x16_bf16 v[52:67], v[80:83], v[48:51], v[52:67]
    v_exp_f32 v36, v36
    v_exp_f32 v37, v37
    v_exp_f32 v38, v38
    v_cvt_pk_bf16_f32 v48, v36, v37
    v_exp_f32 v39, v39
    s_setprio 1
    v_mfma_f32_32x32x16_bf16 v[52:67], v[76:79], v[44:47], v[52:67]
    v_cvt_pk_bf16_f32 v49, v38, v39
    s_mov_b64 exec, s[58:59]
    ds_read_b128 v[80:83], v11 offset:33920
    ds_read_b128 v[76:79], v11 offset:35840
    s_mov_b64 exec, -1
    v_exp_f32 v40, v40
    v_exp_f32 v41, v41
    v_exp_f32 v42, v42
    v_cvt_pk_bf16_f32 v50, v40, v41
    v_exp_f32 v43, v43
    s_setprio 2
    s_waitcnt lgkmcnt(2)
    v_cvt_pk_bf16_f32 v51, v42, v43
    v_mfma_f32_32x32x16_bf16 v[28:43], v[68:71], v[84:87], 0
    ds_read_b128 v[68:71], v9 offset:40960
    v_exp_f32 v12, v12
    v_exp_f32 v13, v13
    v_exp_f32 v14, v14
    v_cvt_pk_bf16_f32 v44, v12, v13
    v_exp_f32 v15, v15
    v_mfma_f32_32x32x8_bf16 v[28:43], v[72:73], v[88:89], v[28:43]
    v_cvt_pk_bf16_f32 v45, v14, v15
    ds_read_b64 v[72:73], v10 offset:40960
    v_exp_f32 v16, v16
    v_exp_f32 v17, v17
    v_exp_f32 v18, v18
    v_cvt_pk_bf16_f32 v46, v16, v17
    v_exp_f32 v19, v19
    s_waitcnt lgkmcnt(2)
    v_cvt_pk_bf16_f32 v47, v18, v19
    v_mfma_f32_32x32x16_bf16 v[52:67], v[80:83], v[48:51], v[52:67]
    v_exp_f32 v20, v20
    v_exp_f32 v21, v21
    v_exp_f32 v22, v22
    v_cvt_pk_bf16_f32 v48, v20, v21
    v_exp_f32 v23, v23
    s_setprio 1
    v_mfma_f32_32x32x16_bf16 v[52:67], v[76:79], v[44:47], v[52:67]
    v_cvt_pk_bf16_f32 v49, v22, v23
    s_mov_b64 exec, s[58:59]
    ds_read_b128 v[80:83], v11 offset:36480
    ds_read_b128 v[76:79], v11 offset:38400
    s_mov_b64 exec, -1
    v_exp_f32 v24, v24
    v_exp_f32 v25, v25
    v_exp_f32 v26, v26
    v_cvt_pk_bf16_f32 v50, v24, v25
    v_exp_f32 v27, v27
    s_setprio 2
    s_waitcnt lgkmcnt(2)
    v_cvt_pk_bf16_f32 v51, v26, v27
    v_mfma_f32_32x32x16_bf16 v[12:27], v[68:71], v[84:87], 0
    ds_read_b128 v[68:71], v9 offset:43520
    v_exp_f32 v28, v28
    v_exp_f32 v29, v29
    v_exp_f32 v30, v30
    v_cvt_pk_bf16_f32 v44, v28, v29
    v_exp_f32 v31, v31
    v_mfma_f32_32x32x8_bf16 v[12:27], v[72:73], v[88:89], v[12:27]
    v_cvt_pk_bf16_f32 v45, v30, v31
    ds_read_b64 v[72:73], v10 offset:43520
    v_exp_f32 v32, v32
    v_exp_f32 v33, v33
    v_exp_f32 v34, v34
    v_cvt_pk_bf16_f32 v46, v32, v33
    v_exp_f32 v35, v35
    s_waitcnt lgkmcnt(2)
    v_cvt_pk_bf16_f32 v47, v34, v35
    v_mfma_f32_32x32x16_bf16 v[52:67], v[80:83], v[48:51], v[52:67]
    v_exp_f32 v36, v36
    v_exp_f32 v37, v37
    v_exp_f32 v38, v38
    v_cvt_pk_bf16_f32 v48, v36, v37
    v_exp_f32 v39, v39
    s_setprio 1
    v_mfma_f32_32x32x16_bf16 v[52:67], v[76:79], v[44:47], v[52:67]
    v_cvt_pk_bf16_f32 v49, v38, v39
    s_mov_b64 exec, s[58:59]
    ds_read_b128 v[80:83], v11 offset:39040
    ds_read_b128 v[76:79], v11 offset:40960
    s_mov_b64 exec, -1
    v_exp_f32 v40, v40
    v_exp_f32 v41, v41
    v_exp_f32 v42, v42
    v_cvt_pk_bf16_f32 v50, v40, v41
    v_exp_f32 v43, v43
    v_add_u32 v9, 40960, v9
    v_cvt_pk_bf16_f32 v51, v42, v43
    v_add_u32 v10, 40960, v10
    v_add_u32 v11, 40960, v11
    s_add_u32 s46, s46, 1
    s_cmp_lt_u32 s46, 4
    s_cbranch_scc1 K2_LOOPB
K2_LOOPX:
    s_waitcnt lgkmcnt(0)
    s_nop 1
    v_mfma_f32_32x32x16_bf16 v[52:67], v[80:83], v[48:51], v[52:67]
    s_nop 15
K2_LEXT:
    v_mov_b32 v1, v60
    v_mov_b32 v2, v60
    s_nop 1
    v_permlane32_swap_b32 v1, v2
    s_nop 1
    v_cmp_gt_u32 vcc, 32, v0
    s_nop 1
    v_cndmask_b32 v1, v60, v2, vcc
    s_cmp_lg_u32 s54, 0
    s_cbranch_scc1 K2_NORM
    v_mov_b32 v4, 0x21800000
    v_cmp_ge_f32 s[4:5], v1, v4
    v_mov_b32 v4, 0x7b800000
    v_cmp_le_f32 s[6:7], v1, v4
    s_and_b64 s[4:5], s[4:5], s[6:7]
    v_add_f32 v28, v52, v53
    v_add_f32 v29, v54, v55
    v_add_f32 v28, v28, v56
    v_add_f32 v29, v29, v57
    v_add_f32 v28, v28, v58
    v_add_f32 v29, v29, v59
    v_add_f32 v28, v28, v60
    v_add_f32 v29, v29, v61
    v_add_f32 v28, v28, v62
    v_add_f32 v29, v29, v63
    v_add_f32 v28, v28, v29
    v_mov_b32 v4, 0x7f800000
    v_cmp_lt_f32 s[6:7], |v28|, v4
    s_and_b64 s[4:5], s[4:5], s[6:7]
    s_cmp_eq_u64 s[4:5], -1
    s_cbranch_scc1 K2_NORM
    v_mov_b32 v9, v8
    v_lshlrev_b32 v10, 3, v3
    v_add_u32 v10, 1024, v10
    v_lshrrev_b32 v2, 5, v0
    v_mul_u32_u24 v11, 20, v2
    v_add_u32 v11, v11, v3
    v_lshlrev_b32 v11, 4, v11
    v_add_u32 v11, 1280, v11
    v_mov_b32 v52, 0
    v_mov_b32 v53, 0
    v_mov_b32 v54, 0
    v_mov_b32 v55, 0
    v_mov_b32 v56, 0
    v_mov_b32 v57, 0
    v_mov_b32 v58, 0
    v_mov_b32 v59, 0
    v_mov_b32 v60, 0
    v_mov_b32 v61, 0
    v_mov_b32 v62, 0
    v_mov_b32 v63, 0
    v_mov_b32 v64, 0
    v_mov_b32 v65, 0
    v_mov_b32 v66, 0
    v_mov_b32 v67, 0
    v_mov_b32 v44, 0
    v_mov_b32 v45, 0
    v_mov_b32 v46, 0
    v_mov_b32 v47, 0
    v_mov_b32 v48, 0
    v_mov_b32 v49, 0
    v_mov_b32 v50, 0
    v_mov_b32 v51, 0
    v_mov_b32 v4, 0xff800000
    v_mov_b32 v72, 0x3f803f80
    v_mov_b32 v73, 0x00003f80
    s_mov_b32 s46, 9699328
K2_FBL:
    buffer_load_dwordx4 v[68:71], v9, s[8:11], s46 offen
    s_mov_b64 exec, 0xffffffff
    buffer_load_dwordx2 v[72:73], v10, s[8:11], s46 offen
    s_mov_b64 exec, -1
    s_waitcnt vmcnt(0)
    v_mfma_f32_32x32x16_bf16 v[12:27], v[68:71], v[84:87], 0
    v_mfma_f32_32x32x8_bf16 v[12:27], v[72:73], v[88:89], v[12:27]
    s_nop 15
    s_nop 3
    v_max3_f32 v4, v4, v12, v13
    v_max3_f32 v4, v4, v14, v15
    v_max3_f32 v4, v4, v16, v17
    v_max3_f32 v4, v4, v18, v19
    v_max3_f32 v4, v4, v20, v21
    v_max3_f32 v4, v4, v22, v23
    v_max3_f32 v4, v4, v24, v25
    v_max3_f32 v4, v4, v26, v27
    s_add_u32 s46, s46, 2560
    s_cmp_lt_u32 s46, 9863168
    s_cbranch_scc1 K2_FBL
    v_mov_b32 v1, v4
    s_nop 1
    v_permlane32_swap_b32 v4, v1
    s_nop 1
    v_max_f32 v4, v4, v1
    v_sub_f32 v4, 0, v4
    v_cvt_pk_bf16_f32 v28, v4, v4
    v_and_b32 v28, 0xffff0000, v28
    v_sub_f32 v4, v4, v28
    v_cvt_pk_bf16_f32 v29, v4, v4
    v_and_b32 v29, 0xffff0000, v29
    v_sub_f32 v4, v4, v29
    v_cvt_pk_bf16_f32 v28, v28, v29
    v_mov_b32 v30, 0
    v_cvt_pk_bf16_f32 v29, v4, v30
    v_cmp_gt_u32 vcc, 32, v0
    s_nop 1
    v_cndmask_b32 v88, v28, v88, vcc
    v_cndmask_b32 v89, v29, v89, vcc
    s_mov_b32 s46, 9699328
K2_FB2:
    buffer_load_dwordx4 v[68:71], v9, s[8:11], s46 offen
    s_mov_b64 exec, 0xffffffff
    buffer_load_dwordx2 v[72:73], v10, s[8:11], s46 offen
    s_mov_b64 exec, -1
    s_mov_b64 exec, s[58:59]
    buffer_load_dwordx4 v[76:79], v11, s[8:11], s46 offen
    buffer_load_dwordx4 v[80:83], v11, s[8:11], s46 offen offset:640
    s_mov_b64 exec, -1
    s_waitcnt vmcnt(0)
    v_mfma_f32_32x32x16_bf16 v[12:27], v[68:71], v[84:87], 0
    v_mfma_f32_32x32x8_bf16 v[12:27], v[72:73], v[88:89], v[12:27]
    s_nop 15
    s_nop 3
    v_exp_f32 v12, v12
    v_exp_f32 v13, v13
    v_exp_f32 v14, v14
    v_exp_f32 v15, v15
    v_exp_f32 v16, v16
    v_exp_f32 v17, v17
    v_exp_f32 v18, v18
    v_exp_f32 v19, v19
    v_exp_f32 v20, v20
    v_exp_f32 v21, v21
    v_exp_f32 v22, v22
    v_exp_f32 v23, v23
    v_exp_f32 v24, v24
    v_exp_f32 v25, v25
    v_exp_f32 v26, v26
    v_exp_f32 v27, v27
    s_nop 1
    v_cvt_pk_bf16_f32 v44, v12, v13
    v_cvt_pk_bf16_f32 v45, v14, v15
    v_cvt_pk_bf16_f32 v46, v16, v17
    v_cvt_pk_bf16_f32 v47, v18, v19
    v_cvt_pk_bf16_f32 v48, v20, v21
    v_cvt_pk_bf16_f32 v49, v22, v23
    v_cvt_pk_bf16_f32 v50, v24, v25
    v_cvt_pk_bf16_f32 v51, v26, v27
    s_nop 1
    v_mfma_f32_32x32x16_bf16 v[52:67], v[76:79], v[44:47], v[52:67]
    v_mfma_f32_32x32x16_bf16 v[52:67], v[80:83], v[48:51], v[52:67]
    s_add_u32 s46, s46, 2560
    s_cmp_lt_u32 s46, 9863168
    s_cbranch_scc1 K2_FB2
    s_nop 15
    s_nop 3
    s_mov_b32 s54, 1
    s_branch K2_LEXT
K2_NORM:
    v_rcp_f32 v1, v1
    v_cmp_gt_u32 vcc, 32, v0
    v_mul_f32 v52, v52, v1
    v_mul_f32 v53, v53, v1
    v_mul_f32 v54, v54, v1
    v_mul_f32 v55, v55, v1
    v_mul_f32 v56, v56, v1
    v_mul_f32 v57, v57, v1
    v_mul_f32 v58, v58, v1
    v_mul_f32 v59, v59, v1
    v_mul_f32 v60, v60, v1
    v_mul_f32 v61, v61, v1
    v_mul_f32 v62, v62, v1
    v_mul_f32 v63, v63, v1
    v_cvt_pk_bf16_f32 v52, v52, v53
    v_cvt_pk_bf16_f32 v53, v54, v55
    v_cvt_pk_bf16_f32 v54, v56, v57
    v_cvt_pk_bf16_f32 v55, v58, v59
    v_cvt_pk_bf16_f32 v56, v60, v61
    v_cvt_pk_bf16_f32 v57, v62, v63
    s_mul_i32 s45, s41, 40960
    s_add_u32 s45, s45, 12894208
    s_lshl_b32 s43, s42, 10
    s_add_u32 s43, s43, s45
    s_lshl_b32 s44, s42, 8
    s_add_u32 s44, s44, s45
    s_add_u32 s44, s44, 32768
    v_lshlrev_b32 v1, 3, v0
    buffer_store_dwordx4 v[52:55], v8, s[8:11], s43 offen sc1
    s_and_saveexec_b64 s[4:5], vcc
    buffer_store_dwordx2 v[56:57], v1, s[8:11], s44 offen sc1
    s_mov_b64 exec, -1
    s_barrier
    s_setprio 0
    s_lshl_b32 s43, s40, 6
    v_add_u32 v126, s43, v0
    v_mul_u32_u24 v125, 3277, v126
    v_lshrrev_b32 v125, 16, v125
    v_mul_u32_u24 v127, 20, v125
    v_sub_u32 v126, v126, v127
    s_mul_i32 s44, s48, 320
    v_lshlrev_b32 v127, 4, v126
    v_add_u32 v127, s44, v127
    buffer_load_dwordx4 v[132:135], v127, s[16:19], 0 offen
    s_lshl_b32 s45, s55, 5
    v_add_u32 v124, s45, v125
    v_mul_u32_u24 v124, 1280, v124
    v_add_u32 v124, v124, v127
    v_cmp_gt_u32 vcc, 32, v125
    v_mov_b32 v127, 0x7ffffff0
    s_nop 0
    v_cndmask_b32 v124, v127, v124, vcc
    buffer_load_dwordx4 v[128:131], v124, s[12:15], 0 offen
    v_min_u32 v125, 31, v125
    v_mul_u32_u24 v125, 656, v125
    v_lshl_add_u32 v125, v126, 5, v125
    s_barrier
    s_branch K2_FINAL
K2_GEMM:
    s_setprio 3
    v_lshlrev_b32 v2, 4, v0
    s_lshl_b32 s44, s47, 10
    s_waitcnt lgkmcnt(0)
    s_mov_b32 s8, s4
    s_and_b32 s9, s5, 0xffff
    s_mov_b32 s10, 21872640
    s_mov_b32 s11, 0x20000
    s_add_u32 m0, s44, 0
    s_add_u32 s45, s44, 9699328
    buffer_load_dwordx4 v2, s[8:11], s45 offen lds
    s_add_u32 m0, s44, 4096
    s_add_u32 s45, s44, 9703424
    buffer_load_dwordx4 v2, s[8:11], s45 offen lds
    s_add_u32 m0, s44, 8192
    s_add_u32 s45, s44, 9707520
    buffer_load_dwordx4 v2, s[8:11], s45 offen lds
    s_add_u32 m0, s44, 12288
    s_add_u32 s45, s44, 9711616
    buffer_load_dwordx4 v2, s[8:11], s45 offen lds
    s_add_u32 m0, s44, 16384
    s_add_u32 s45, s44, 9715712
    buffer_load_dwordx4 v2, s[8:11], s45 offen lds
    s_add_u32 m0, s44, 20480
    s_add_u32 s45, s44, 9719808
    buffer_load_dwordx4 v2, s[8:11], s45 offen lds
    s_add_u32 m0, s44, 24576
    s_add_u32 s45, s44, 9723904
    buffer_load_dwordx4 v2, s[8:11], s45 offen lds
    s_mov_b32 s12, s6
    s_and_b32 s13, s7, 0xffff
    s_mov_b32 s14, 2621440
    s_mov_b32 s15, 0x20000
    s_mov_b32 s16, s24
    s_and_b32 s17, s25, 0xffff
    s_mov_b32 s18, 1280
    s_mov_b32 s19, 0x20000
    s_mov_b32 s20, s26
    s_and_b32 s21, s27, 0xffff
    s_mov_b32 s22, 2621440
    s_mov_b32 s23, 0x20000
    v_mov_b32 v4, 0
    v_mov_b32 v5, 0
    v_mov_b32 v6, 0
    v_mov_b32 v7, 0
    v_mov_b32 v8, 0
    v_mov_b32 v9, 0
    v_mov_b32 v10, 0
    v_mov_b32 v11, 0
    v_mov_b32 v12, 0
    v_mov_b32 v13, 0
    v_mov_b32 v14, 0
    v_mov_b32 v15, 0
    v_mov_b32 v16, 0
    v_mov_b32 v17, 0
    v_mov_b32 v18, 0
    v_mov_b32 v19, 0
    v_mov_b32 v20, 0
    v_mov_b32 v21, 0
    v_mov_b32 v22, 0
    v_mov_b32 v23, 0
    v_mov_b32 v24, 0
    v_mov_b32 v25, 0
    v_mov_b32 v26, 0
    v_mov_b32 v27, 0
    v_mov_b32 v28, 0
    v_mov_b32 v29, 0
    v_mov_b32 v30, 0
    v_mov_b32 v31, 0
    v_mov_b32 v32, 0
    v_mov_b32 v33, 0
    v_mov_b32 v34, 0
    v_mov_b32 v35, 0
    v_mov_b32 v36, 0
    v_mov_b32 v37, 0
    v_mov_b32 v38, 0
    v_mov_b32 v39, 0
    v_mov_b32 v40, 0
    v_mov_b32 v41, 0
    v_mov_b32 v42, 0
    v_mov_b32 v43, 0
    v_mov_b32 v44, 0
    v_mov_b32 v45, 0
    v_mov_b32 v46, 0
    v_mov_b32 v47, 0
    v_mov_b32 v48, 0
    v_mov_b32 v49, 0
    v_mov_b32 v50, 0
    v_mov_b32 v51, 0
    v_mov_b32 v52, 0
    v_mov_b32 v53, 0
    v_mov_b32 v54, 0
    v_mov_b32 v55, 0
    v_mov_b32 v56, 0
    v_mov_b32 v57, 0
    v_mov_b32 v58, 0
    v_mov_b32 v59, 0
    v_mov_b32 v60, 0
    v_mov_b32 v61, 0
    v_mov_b32 v62, 0
    v_mov_b32 v63, 0
    v_mov_b32 v64, 0
    v_mov_b32 v65, 0
    v_mov_b32 v66, 0
    v_mov_b32 v67, 0
    v_mov_b32 v68, 0
    v_mov_b32 v69, 0
    v_mov_b32 v70, 0
    v_mov_b32 v71, 0
    v_mov_b32 v72, 0
    v_mov_b32 v73, 0
    v_mov_b32 v74, 0
    v_mov_b32 v75, 0
    v_mov_b32 v76, 0
    v_mov_b32 v77, 0
    v_mov_b32 v78, 0
    v_mov_b32 v79, 0
    v_mov_b32 v80, 0
    v_mov_b32 v81, 0
    v_mov_b32 v82, 0
    v_mov_b32 v83, 0
    s_waitcnt vmcnt(0)
    s_barrier
    s_add_u32 m0, s44, 28672
    s_add_u32 s45, s44, 9728000
    buffer_load_dwordx4 v2, s[8:11], s45 offen lds
    s_add_u32 m0, s44, 32768
    s_add_u32 s45, s44, 9732096
    buffer_load_dwordx4 v2, s[8:11], s45 offen lds
    s_add_u32 m0, s44, 36864
    s_add_u32 s45, s44, 9736192
    buffer_load_dwordx4 v2, s[8:11], s45 offen lds
    s_add_u32 m0, s44, 40960
    s_add_u32 s45, s44, 9740288
    buffer_load_dwordx4 v2, s[8:11], s45 offen lds
    s_add_u32 m0, s44, 45056
    s_add_u32 s45, s44, 9744384
    buffer_load_dwordx4 v2, s[8:11], s45 offen lds
    s_add_u32 m0, s44, 49152
    s_add_u32 s45, s44, 9748480
    buffer_load_dwordx4 v2, s[8:11], s45 offen lds
    s_add_u32 m0, s44, 53248
    s_add_u32 s45, s44, 9752576
    buffer_load_dwordx4 v2, s[8:11], s45 offen lds
    s_add_u32 m0, s44, 57344
    s_add_u32 s45, s44, 9756672
    buffer_load_dwordx4 v2, s[8:11], s45 offen lds
    s_add_u32 m0, s44, 61440
    s_add_u32 s45, s44, 9760768
    buffer_load_dwordx4 v2, s[8:11], s45 offen lds
    s_add_u32 m0, s44, 65536
    s_add_u32 s45, s44, 9764864
    buffer_load_dwordx4 v2, s[8:11], s45 offen lds
    s_add_u32 m0, s44, 69632
    s_add_u32 s45, s44, 9768960
    buffer_load_dwordx4 v2, s[8:11], s45 offen lds
    s_add_u32 m0, s44, 73728
    s_add_u32 s45, s44, 9773056
    buffer_load_dwordx4 v2, s[8:11], s45 offen lds
    s_add_u32 m0, s44, 77824
    s_add_u32 s45, s44, 9777152
    buffer_load_dwordx4 v2, s[8:11], s45 offen lds
    s_add_u32 m0, s44, 81920
    s_add_u32 s45, s44, 9781248
    buffer_load_dwordx4 v2, s[8:11], s45 offen lds
    s_add_u32 m0, s44, 86016
    s_add_u32 s45, s44, 9785344
    buffer_load_dwordx4 v2, s[8:11], s45 offen lds
    s_add_u32 m0, s44, 90112
    s_add_u32 s45, s44, 9789440
    buffer_load_dwordx4 v2, s[8:11], s45 offen lds
    s_add_u32 m0, s44, 94208
    s_add_u32 s45, s44, 9793536
    buffer_load_dwordx4 v2, s[8:11], s45 offen lds
    s_add_u32 m0, s44, 98304
    s_add_u32 s45, s44, 9797632
    buffer_load_dwordx4 v2, s[8:11], s45 offen lds
    s_add_u32 m0, s44, 102400
    s_add_u32 s45, s44, 9801728
    buffer_load_dwordx4 v2, s[8:11], s45 offen lds
    s_add_u32 m0, s44, 106496
    s_add_u32 s45, s44, 9805824
    buffer_load_dwordx4 v2, s[8:11], s45 offen lds
    s_add_u32 m0, s44, 110592
    s_add_u32 s45, s44, 9809920
    buffer_load_dwordx4 v2, s[8:11], s45 offen lds
    s_add_u32 m0, s44, 114688
    s_add_u32 s45, s44, 9814016
    buffer_load_dwordx4 v2, s[8:11], s45 offen lds
    s_add_u32 m0, s44, 118784
    s_add_u32 s45, s44, 9818112
    buffer_load_dwordx4 v2, s[8:11], s45 offen lds
    s_add_u32 m0, s44, 122880
    s_add_u32 s45, s44, 9822208
    buffer_load_dwordx4 v2, s[8:11], s45 offen lds
    s_add_u32 m0, s44, 126976
    s_add_u32 s45, s44, 9826304
    buffer_load_dwordx4 v2, s[8:11], s45 offen lds
    s_add_u32 m0, s44, 131072
    s_add_u32 s45, s44, 9830400
    buffer_load_dwordx4 v2, s[8:11], s45 offen lds
    s_add_u32 m0, s44, 135168
    s_add_u32 s45, s44, 9834496
    buffer_load_dwordx4 v2, s[8:11], s45 offen lds
    s_add_u32 m0, s44, 139264
    s_add_u32 s45, s44, 9838592
    buffer_load_dwordx4 v2, s[8:11], s45 offen lds
    s_add_u32 m0, s44, 143360
    s_add_u32 s45, s44, 9842688
    buffer_load_dwordx4 v2, s[8:11], s45 offen lds
    s_add_u32 m0, s44, 147456
    s_add_u32 s45, s44, 9846784
    buffer_load_dwordx4 v2, s[8:11], s45 offen lds
    s_add_u32 m0, s44, 151552
    s_add_u32 s45, s44, 9850880
    buffer_load_dwordx4 v2, s[8:11], s45 offen lds
    s_add_u32 m0, s44, 155648
    s_add_u32 s45, s44, 9854976
    buffer_load_dwordx4 v2, s[8:11], s45 offen lds
    s_add_u32 m0, s44, 159744
    s_add_u32 s45, s44, 9859072
    buffer_load_dwordx4 v2, s[8:11], s45 offen lds
    s_waitcnt vmcnt(0)
    s_barrier
    s_setprio 0
    s_mul_i32 s49, s48, 552960
    s_mul_i32 s43, s47, 138240
    s_add_u32 s49, s49, s43
    s_add_u32 s49, s49, 9863168
    s_mul_i32 s50, s55, 110592
    s_mul_i32 s43, s47, 27648
    s_add_u32 s50, s50, s43
    s_add_u32 s50, s50, 2621440
    buffer_load_dwordx4 v[124:127], v2, s[8:11], s50 offen
    buffer_load_dwordx4 v[84:87], v2, s[8:11], s49 offen offset:0
    buffer_load_dwordx4 v[88:91], v2, s[8:11], s49 offen offset:1024
    buffer_load_dwordx4 v[92:95], v2, s[8:11], s49 offen offset:2048
    buffer_load_dwordx4 v[96:99], v2, s[8:11], s49 offen offset:3072
    s_add_u32 s51, s49, 4096
    buffer_load_dwordx4 v[100:103], v2, s[8:11], s51 offen
    s_add_u32 s49, s49, 5120
    s_add_u32 s50, s50, 1024
    s_mov_b32 s46, 0
K2_GL:
    buffer_load_dwordx4 v[128:131], v2, s[8:11], s50 offen
    buffer_load_dwordx4 v[104:107], v2, s[8:11], s49 offen offset:0
    buffer_load_dwordx4 v[108:111], v2, s[8:11], s49 offen offset:1024
    buffer_load_dwordx4 v[112:115], v2, s[8:11], s49 offen offset:2048
    buffer_load_dwordx4 v[116:119], v2, s[8:11], s49 offen offset:3072
    s_add_u32 s51, s49, 4096
    buffer_load_dwordx4 v[120:123], v2, s[8:11], s51 offen
    s_add_u32 s49, s49, 5120
    s_add_u32 s50, s50, 1024
    s_waitcnt vmcnt(6)
    v_mfma_f32_32x32x16_bf16 v[4:19], v[84:87], v[124:127], v[4:19]
    v_mfma_f32_32x32x16_bf16 v[20:35], v[88:91], v[124:127], v[20:35]
    v_mfma_f32_32x32x16_bf16 v[36:51], v[92:95], v[124:127], v[36:51]
    v_mfma_f32_32x32x16_bf16 v[52:67], v[96:99], v[124:127], v[52:67]
    v_mfma_f32_32x32x16_bf16 v[68:83], v[100:103], v[124:127], v[68:83]
    buffer_load_dwordx4 v[124:127], v2, s[8:11], s50 offen
    buffer_load_dwordx4 v[84:87], v2, s[8:11], s49 offen offset:0
    buffer_load_dwordx4 v[88:91], v2, s[8:11], s49 offen offset:1024
    buffer_load_dwordx4 v[92:95], v2, s[8:11], s49 offen offset:2048
    buffer_load_dwordx4 v[96:99], v2, s[8:11], s49 offen offset:3072
    s_add_u32 s51, s49, 4096
    buffer_load_dwordx4 v[100:103], v2, s[8:11], s51 offen
    s_add_u32 s49, s49, 5120
    s_add_u32 s50, s50, 1024
    s_waitcnt vmcnt(6)
    v_mfma_f32_32x32x16_bf16 v[4:19], v[104:107], v[128:131], v[4:19]
    v_mfma_f32_32x32x16_bf16 v[20:35], v[108:111], v[128:131], v[20:35]
    v_mfma_f32_32x32x16_bf16 v[36:51], v[112:115], v[128:131], v[36:51]
    v_mfma_f32_32x32x16_bf16 v[52:67], v[116:119], v[128:131], v[52:67]
    v_mfma_f32_32x32x16_bf16 v[68:83], v[120:123], v[128:131], v[68:83]
    s_add_u32 s46, s46, 1
    s_cmp_lt_u32 s46, 13
    s_cbranch_scc1 K2_GL
    s_waitcnt vmcnt(0)
    v_mfma_f32_32x32x16_bf16 v[4:19], v[84:87], v[124:127], v[4:19]
    v_mfma_f32_32x32x16_bf16 v[20:35], v[88:91], v[124:127], v[20:35]
    v_mfma_f32_32x32x16_bf16 v[36:51], v[92:95], v[124:127], v[36:51]
    v_mfma_f32_32x32x16_bf16 v[52:67], v[96:99], v[124:127], v[52:67]
    v_mfma_f32_32x32x16_bf16 v[68:83], v[100:103], v[124:127], v[68:83]
    s_mul_i32 s49, s48, 204800
    s_mul_i32 s43, s47, 51200
    s_add_u32 s49, s49, s43
    s_add_u32 s49, s49, 12075008
    buffer_load_dwordx4 v[84:87], v2, s[8:11], s49 offen offset:0
    buffer_load_dwordx4 v[88:91], v2, s[8:11], s49 offen offset:1024
    buffer_load_dwordx4 v[92:95], v2, s[8:11], s49 offen offset:2048
    buffer_load_dwordx4 v[96:99], v2, s[8:11], s49 offen offset:3072
    s_add_u32 s51, s49, 4096
    buffer_load_dwordx4 v[100:103], v2, s[8:11], s51 offen
    s_add_u32 s49, s49, 5120
    buffer_load_dwordx4 v[104:107], v2, s[8:11], s49 offen offset:0
    buffer_load_dwordx4 v[108:111], v2, s[8:11], s49 offen offset:1024
    buffer_load_dwordx4 v[112:115], v2, s[8:11], s49 offen offset:2048
    buffer_load_dwordx4 v[116:119], v2, s[8:11], s49 offen offset:3072
    s_add_u32 s51, s49, 4096
    buffer_load_dwordx4 v[120:123], v2, s[8:11], s51 offen
    s_add_u32 s49, s49, 5120
    v_lshlrev_b32 v1, 7, v0
    s_add_u32 s51, s49, 0
    buffer_load_dword v132, v1, s[8:11], s51 offen
    s_add_u32 s51, s49, 8192
    buffer_load_dword v133, v1, s[8:11], s51 offen
    s_add_u32 s51, s49, 16384
    buffer_load_dword v134, v1, s[8:11], s51 offen
    s_add_u32 s51, s49, 24576
    buffer_load_dword v135, v1, s[8:11], s51 offen
    s_add_u32 s51, s49, 32768
    buffer_load_dword v136, v1, s[8:11], s51 offen
    s_mul_i32 s57, s55, 40960
    s_add_u32 s57, s57, 12894208
    s_lshl_b32 s43, s47, 13
    s_add_u32 s50, s57, s43
    s_lshl_b32 s43, s47, 11
    s_add_u32 s57, s57, s43
    s_add_u32 s57, s57, 32768
    s_mul_i32 s44, s47, 35840
    v_add_u32 v3, s44, v2
    v_and_b32 v165, 31, v0
    v_lshlrev_b32 v165, 3, v165
    v_lshrrev_b32 v164, 5, v0
    v_lshl_add_u32 v165, v164, 8, v165
    v_and_b32 v164, 7, v0
    v_lshlrev_b32 v164, 8, v164
    v_lshrrev_b32 v1, 3, v0
    v_lshl_add_u32 v164, v1, 5, v164
    s_barrier
    s_add_u32 m0, s44, 0
    s_add_u32 s45, s49, 0
    buffer_load_dwordx4 v2, s[8:11], s45 offen lds
    s_add_u32 m0, s44, 1024
    s_add_u32 s45, s49, 1024
    buffer_load_dwordx4 v2, s[8:11], s45 offen lds
    s_add_u32 m0, s44, 2048
    s_add_u32 s45, s49, 2048
    buffer_load_dwordx4 v2, s[8:11], s45 offen lds
    s_add_u32 m0, s44, 3072
    s_add_u32 s45, s49, 3072
    buffer_load_dwordx4 v2, s[8:11], s45 offen lds
    s_add_u32 m0, s44, 4096
    s_add_u32 s45, s49, 4096
    buffer_load_dwordx4 v2, s[8:11], s45 offen lds
    s_add_u32 m0, s44, 5120
    s_add_u32 s45, s49, 5120
    buffer_load_dwordx4 v2, s[8:11], s45 offen lds
    s_add_u32 m0, s44, 6144
    s_add_u32 s45, s49, 6144
    buffer_load_dwordx4 v2, s[8:11], s45 offen lds
    s_add_u32 m0, s44, 7168
    s_add_u32 s45, s49, 7168
    buffer_load_dwordx4 v2, s[8:11], s45 offen lds
    s_add_u32 m0, s44, 8192
    s_add_u32 s45, s49, 8192
    buffer_load_dwordx4 v2, s[8:11], s45 offen lds
    s_add_u32 m0, s44, 9216
    s_add_u32 s45, s49, 9216
    buffer_load_dwordx4 v2, s[8:11], s45 offen lds
    s_add_u32 m0, s44, 10240
    s_add_u32 s45, s49, 10240
    buffer_load_dwordx4 v2, s[8:11], s45 offen lds
    s_add_u32 m0, s44, 11264
    s_add_u32 s45, s49, 11264
    buffer_load_dwordx4 v2, s[8:11], s45 offen lds
    s_add_u32 m0, s44, 12288
    s_add_u32 s45, s49, 12288
    buffer_load_dwordx4 v2, s[8:11], s45 offen lds
    s_add_u32 m0, s44, 13312
    s_add_u32 s45, s49, 13312
    buffer_load_dwordx4 v2, s[8:11], s45 offen lds
    s_add_u32 m0, s44, 14336
    s_add_u32 s45, s49, 14336
    buffer_load_dwordx4 v2, s[8:11], s45 offen lds
    s_add_u32 m0, s44, 15360
    s_add_u32 s45, s49, 15360
    buffer_load_dwordx4 v2, s[8:11], s45 offen lds
    s_add_u32 m0, s44, 16384
    s_add_u32 s45, s49, 16384
    buffer_load_dwordx4 v2, s[8:11], s45 offen lds
    s_add_u32 m0, s44, 17408
    s_add_u32 s45, s49, 17408
    buffer_load_dwordx4 v2, s[8:11], s45 offen lds
    s_add_u32 m0, s44, 18432
    s_add_u32 s45, s49, 18432
    buffer_load_dwordx4 v2, s[8:11], s45 offen lds
    s_add_u32 m0, s44, 19456
    s_add_u32 s45, s49, 19456
    buffer_load_dwordx4 v2, s[8:11], s45 offen lds
    s_add_u32 m0, s44, 20480
    s_add_u32 s45, s49, 20480
    buffer_load_dwordx4 v2, s[8:11], s45 offen lds
    s_add_u32 m0, s44, 21504
    s_add_u32 s45, s49, 21504
    buffer_load_dwordx4 v2, s[8:11], s45 offen lds
    s_add_u32 m0, s44, 22528
    s_add_u32 s45, s49, 22528
    buffer_load_dwordx4 v2, s[8:11], s45 offen lds
    s_add_u32 m0, s44, 23552
    s_add_u32 s45, s49, 23552
    buffer_load_dwordx4 v2, s[8:11], s45 offen lds
    s_add_u32 m0, s44, 24576
    s_add_u32 s45, s49, 24576
    buffer_load_dwordx4 v2, s[8:11], s45 offen lds
    s_add_u32 m0, s44, 25600
    s_add_u32 s45, s49, 25600
    buffer_load_dwordx4 v2, s[8:11], s45 offen lds
    s_add_u32 m0, s44, 26624
    s_add_u32 s45, s49, 26624
    buffer_load_dwordx4 v2, s[8:11], s45 offen lds
    s_add_u32 m0, s44, 27648
    s_add_u32 s45, s49, 27648
    buffer_load_dwordx4 v2, s[8:11], s45 offen lds
    s_add_u32 m0, s44, 28672
    s_add_u32 s45, s49, 28672
    buffer_load_dwordx4 v2, s[8:11], s45 offen lds
    s_add_u32 m0, s44, 29696
    s_add_u32 s45, s49, 29696
    buffer_load_dwordx4 v2, s[8:11], s45 offen lds
    s_add_u32 m0, s44, 30720
    s_add_u32 s45, s49, 30720
    buffer_load_dwordx4 v2, s[8:11], s45 offen lds
    s_add_u32 m0, s44, 31744
    s_add_u32 s45, s49, 31744
    buffer_load_dwordx4 v2, s[8:11], s45 offen lds
    s_add_u32 m0, s44, 32768
    s_add_u32 s45, s49, 32768
    buffer_load_dwordx4 v2, s[8:11], s45 offen lds
    s_add_u32 m0, s44, 33792
    s_add_u32 s45, s49, 33792
    buffer_load_dwordx4 v2, s[8:11], s45 offen lds
    s_add_u32 m0, s44, 34816
    s_add_u32 s45, s49, 34816
    buffer_load_dwordx4 v2, s[8:11], s45 offen lds
    s_barrier
    s_setprio 3
    s_mul_i32 s44, s47, 5120
    s_add_u32 m0, s44, 143360
    s_add_u32 s45, s49, 35840
    buffer_load_dwordx4 v2, s[8:11], s45 offen lds
    s_add_u32 m0, s44, 144384
    s_add_u32 s45, s49, 36864
    buffer_load_dwordx4 v2, s[8:11], s45 offen lds
    s_add_u32 m0, s44, 145408
    s_add_u32 s45, s49, 37888
    buffer_load_dwordx4 v2, s[8:11], s45 offen lds
    s_add_u32 m0, s44, 146432
    s_add_u32 s45, s49, 38912
    buffer_load_dwordx4 v2, s[8:11], s45 offen lds
    s_add_u32 m0, s44, 147456
    s_add_u32 s45, s49, 39936
    buffer_load_dwordx4 v2, s[8:11], s45 offen lds
    v_add_u32 v166, s44, v2
    v_add_u32 v166, 143360, v166
    s_mov_b32 s56, 0
    s_sleep 4
K2_POLL:
    buffer_load_dwordx4 v[124:127], v2, s[8:11], s50 offen offset:0 sc1
    buffer_load_dwordx4 v[128:131], v2, s[8:11], s50 offen offset:1024 sc1
    buffer_load_dwordx4 v[132:135], v2, s[8:11], s50 offen offset:2048 sc1
    buffer_load_dwordx4 v[136:139], v2, s[8:11], s50 offen offset:3072 sc1
    s_add_u32 s51, s50, 4096
    buffer_load_dwordx4 v[140:143], v2, s[8:11], s51 offen offset:0 sc1
    buffer_load_dwordx4 v[144:147], v2, s[8:11], s51 offen offset:1024 sc1
    buffer_load_dwordx4 v[148:151], v2, s[8:11], s51 offen offset:2048 sc1
    buffer_load_dwordx4 v[152:155], v2, s[8:11], s51 offen offset:3072 sc1
    buffer_load_dwordx2 v[156:157], v165, s[8:11], s57 offen offset:0 sc1
    buffer_load_dwordx2 v[158:159], v165, s[8:11], s57 offen offset:512 sc1
    buffer_load_dwordx2 v[160:161], v165, s[8:11], s57 offen offset:1024 sc1
    buffer_load_dwordx2 v[162:163], v165, s[8:11], s57 offen offset:1536 sc1
    s_waitcnt vmcnt(0)
    v_max_u32 v1, v124, v125
    v_max3_u32 v1, v1, v126, v127
    v_max3_u32 v1, v1, v128, v129
    v_max3_u32 v1, v1, v130, v131
    v_max3_u32 v1, v1, v132, v133
    v_max3_u32 v1, v1, v134, v135
    v_max3_u32 v1, v1, v136, v137
    v_max3_u32 v1, v1, v138, v139
    v_max3_u32 v1, v1, v140, v141
    v_max3_u32 v1, v1, v142, v143
    v_max3_u32 v1, v1, v144, v145
    v_max3_u32 v1, v1, v146, v147
    v_max3_u32 v1, v1, v148, v149
    v_max3_u32 v1, v1, v150, v151
    v_max3_u32 v1, v1, v152, v153
    v_max3_u32 v1, v1, v154, v155
    v_max3_u32 v1, v1, v156, v157
    v_max3_u32 v1, v1, v158, v159
    v_max3_u32 v1, v1, v160, v161
    v_max3_u32 v1, v1, v162, v163
    v_cmp_eq_u32 vcc, -1, v1
    s_nop 1
    s_cmp_eq_u64 vcc, 0
    s_cbranch_scc1 K2_GOT
    s_add_u32 s56, s56, 1
    s_sleep 2
    s_cmp_lt_u32 s56, 0x40000
    s_cbranch_scc1 K2_POLL
K2_GOT:
    v_and_b32 v164, 31, v0
    v_mul_u32_u24 v164, 656, v164
    v_lshrrev_b32 v165, 5, v0
    v_lshl_add_u32 v164, v165, 4, v164
    s_mul_i32 s43, s47, 35840
    v_add_u32 v164, s43, v164
    v_mfma_f32_32x32x16_bf16 v[4:19], v[84:87], v[124:127], v[4:19]
    v_mfma_f32_32x32x16_bf16 v[20:35], v[88:91], v[124:127], v[20:35]
    v_mfma_f32_32x32x16_bf16 v[36:51], v[92:95], v[124:127], v[36:51]
    v_mfma_f32_32x32x16_bf16 v[52:67], v[96:99], v[124:127], v[52:67]
    v_mfma_f32_32x32x16_bf16 v[68:83], v[100:103], v[124:127], v[68:83]
    ds_read_b128 v[84:87], v3 offset:0
    ds_read_b128 v[88:91], v3 offset:1024
    ds_read_b128 v[92:95], v3 offset:2048
    ds_read_b128 v[96:99], v3 offset:3072
    ds_read_b128 v[100:103], v3 offset:4096
    v_mfma_f32_32x32x16_bf16 v[4:19], v[104:107], v[128:131], v[4:19]
    v_mfma_f32_32x32x16_bf16 v[20:35], v[108:111], v[128:131], v[20:35]
    v_mfma_f32_32x32x16_bf16 v[36:51], v[112:115], v[128:131], v[36:51]
    v_mfma_f32_32x32x16_bf16 v[52:67], v[116:119], v[128:131], v[52:67]
    v_mfma_f32_32x32x16_bf16 v[68:83], v[120:123], v[128:131], v[68:83]
    ds_read_b128 v[104:107], v3 offset:5120
    ds_read_b128 v[108:111], v3 offset:6144
    ds_read_b128 v[112:115], v3 offset:7168
    ds_read_b128 v[116:119], v3 offset:8192
    ds_read_b128 v[120:123], v3 offset:9216
    s_waitcnt lgkmcnt(5)
    v_mfma_f32_32x32x16_bf16 v[4:19], v[84:87], v[132:135], v[4:19]
    v_mfma_f32_32x32x16_bf16 v[20:35], v[88:91], v[132:135], v[20:35]
    v_mfma_f32_32x32x16_bf16 v[36:51], v[92:95], v[132:135], v[36:51]
    v_mfma_f32_32x32x16_bf16 v[52:67], v[96:99], v[132:135], v[52:67]
    v_mfma_f32_32x32x16_bf16 v[68:83], v[100:103], v[132:135], v[68:83]
    ds_read_b128 v[84:87], v3 offset:10240
    ds_read_b128 v[88:91], v3 offset:11264
    ds_read_b128 v[92:95], v3 offset:12288
    ds_read_b128 v[96:99], v3 offset:13312
    ds_read_b128 v[100:103], v3 offset:14336
    s_waitcnt lgkmcnt(5)
    v_mfma_f32_32x32x16_bf16 v[4:19], v[104:107], v[136:139], v[4:19]
    v_mfma_f32_32x32x16_bf16 v[20:35], v[108:111], v[136:139], v[20:35]
    v_mfma_f32_32x32x16_bf16 v[36:51], v[112:115], v[136:139], v[36:51]
    v_mfma_f32_32x32x16_bf16 v[52:67], v[116:119], v[136:139], v[52:67]
    v_mfma_f32_32x32x16_bf16 v[68:83], v[120:123], v[136:139], v[68:83]
    ds_read_b128 v[104:107], v3 offset:15360
    ds_read_b128 v[108:111], v3 offset:16384
    ds_read_b128 v[112:115], v3 offset:17408
    ds_read_b128 v[116:119], v3 offset:18432
    ds_read_b128 v[120:123], v3 offset:19456
    s_lshl_b32 s43, s40, 6
    v_add_u32 v126, s43, v0
    v_mul_u32_u24 v125, 3277, v126
    v_lshrrev_b32 v125, 16, v125
    v_mul_u32_u24 v127, 20, v125
    v_sub_u32 v126, v126, v127
    s_mul_i32 s44, s48, 320
    v_lshlrev_b32 v127, 4, v126
    v_add_u32 v127, s44, v127
    buffer_load_dwordx4 v[132:135], v127, s[16:19], 0 offen
    s_lshl_b32 s45, s55, 5
    v_add_u32 v124, s45, v125
    v_mul_u32_u24 v124, 1280, v124
    v_add_u32 v124, v124, v127
    v_cmp_gt_u32 vcc, 32, v125
    v_mov_b32 v127, 0x7ffffff0
    s_nop 0
    v_cndmask_b32 v124, v127, v124, vcc
    buffer_load_dwordx4 v[128:131], v124, s[12:15], 0 offen
    v_min_u32 v125, 31, v125
    v_mul_u32_u24 v125, 656, v125
    v_lshl_add_u32 v125, v126, 5, v125
    s_waitcnt lgkmcnt(5)
    v_mfma_f32_32x32x16_bf16 v[4:19], v[84:87], v[140:143], v[4:19]
    v_mfma_f32_32x32x16_bf16 v[20:35], v[88:91], v[140:143], v[20:35]
    v_mfma_f32_32x32x16_bf16 v[36:51], v[92:95], v[140:143], v[36:51]
    v_mfma_f32_32x32x16_bf16 v[52:67], v[96:99], v[140:143], v[52:67]
    v_mfma_f32_32x32x16_bf16 v[68:83], v[100:103], v[140:143], v[68:83]
    ds_read_b128 v[84:87], v3 offset:20480
    ds_read_b128 v[88:91], v3 offset:21504
    ds_read_b128 v[92:95], v3 offset:22528
    ds_read_b128 v[96:99], v3 offset:23552
    ds_read_b128 v[100:103], v3 offset:24576
    s_waitcnt lgkmcnt(5)
    v_mfma_f32_32x32x16_bf16 v[4:19], v[104:107], v[144:147], v[4:19]
    v_mfma_f32_32x32x16_bf16 v[20:35], v[108:111], v[144:147], v[20:35]
    v_mfma_f32_32x32x16_bf16 v[36:51], v[112:115], v[144:147], v[36:51]
    v_mfma_f32_32x32x16_bf16 v[52:67], v[116:119], v[144:147], v[52:67]
    v_mfma_f32_32x32x16_bf16 v[68:83], v[120:123], v[144:147], v[68:83]
    ds_read_b128 v[104:107], v3 offset:25600
    ds_read_b128 v[108:111], v3 offset:26624
    ds_read_b128 v[112:115], v3 offset:27648
    ds_read_b128 v[116:119], v3 offset:28672
    ds_read_b128 v[120:123], v3 offset:29696
    s_waitcnt lgkmcnt(5)
    v_mfma_f32_32x32x16_bf16 v[4:19], v[84:87], v[148:151], v[4:19]
    v_mfma_f32_32x32x16_bf16 v[20:35], v[88:91], v[148:151], v[20:35]
    v_mfma_f32_32x32x16_bf16 v[36:51], v[92:95], v[148:151], v[36:51]
    v_mfma_f32_32x32x16_bf16 v[52:67], v[96:99], v[148:151], v[52:67]
    v_mfma_f32_32x32x16_bf16 v[68:83], v[100:103], v[148:151], v[68:83]
    ds_read_b128 v[84:87], v3 offset:30720
    ds_read_b128 v[88:91], v3 offset:31744
    ds_read_b128 v[92:95], v3 offset:32768
    ds_read_b128 v[96:99], v3 offset:33792
    ds_read_b128 v[100:103], v3 offset:34816
    s_waitcnt lgkmcnt(5)
    v_mfma_f32_32x32x16_bf16 v[4:19], v[104:107], v[152:155], v[4:19]
    v_mfma_f32_32x32x16_bf16 v[20:35], v[108:111], v[152:155], v[20:35]
    v_mfma_f32_32x32x16_bf16 v[36:51], v[112:115], v[152:155], v[36:51]
    v_mfma_f32_32x32x16_bf16 v[52:67], v[116:119], v[152:155], v[52:67]
    v_mfma_f32_32x32x16_bf16 v[68:83], v[120:123], v[152:155], v[68:83]
    ds_read_b128 v[104:107], v166 offset:0
    ds_read_b128 v[108:111], v166 offset:1024
    ds_read_b128 v[112:115], v166 offset:2048
    ds_read_b128 v[116:119], v166 offset:3072
    ds_read_b128 v[120:123], v166 offset:4096
    s_waitcnt lgkmcnt(5)
    v_mfma_f32_32x32x16_bf16 v[4:19], v[84:87], v[156:159], v[4:19]
    v_mfma_f32_32x32x16_bf16 v[20:35], v[88:91], v[156:159], v[20:35]
    v_mfma_f32_32x32x16_bf16 v[36:51], v[92:95], v[156:159], v[36:51]
    v_mfma_f32_32x32x16_bf16 v[52:67], v[96:99], v[156:159], v[52:67]
    v_mfma_f32_32x32x16_bf16 v[68:83], v[100:103], v[156:159], v[68:83]
    s_waitcnt lgkmcnt(0)
    v_mfma_f32_32x32x16_bf16 v[4:19], v[104:107], v[160:163], v[4:19]
    v_mfma_f32_32x32x16_bf16 v[20:35], v[108:111], v[160:163], v[20:35]
    v_mfma_f32_32x32x16_bf16 v[36:51], v[112:115], v[160:163], v[36:51]
    v_mfma_f32_32x32x16_bf16 v[52:67], v[116:119], v[160:163], v[52:67]
    v_mfma_f32_32x32x16_bf16 v[68:83], v[120:123], v[160:163], v[68:83]
    s_nop 15
    ds_write_b128 v164, v[4:7] offset:0
    ds_write_b128 v164, v[8:11] offset:32
    ds_write_b128 v164, v[12:15] offset:64
    ds_write_b128 v164, v[16:19] offset:96
    ds_write_b128 v164, v[20:23] offset:128
    ds_write_b128 v164, v[24:27] offset:160
    ds_write_b128 v164, v[28:31] offset:192
    ds_write_b128 v164, v[32:35] offset:224
    ds_write_b128 v164, v[36:39] offset:256
    ds_write_b128 v164, v[40:43] offset:288
    ds_write_b128 v164, v[44:47] offset:320
    ds_write_b128 v164, v[48:51] offset:352
    ds_write_b128 v164, v[52:55] offset:384
    ds_write_b128 v164, v[56:59] offset:416
    ds_write_b128 v164, v[60:63] offset:448
    ds_write_b128 v164, v[64:67] offset:480
    ds_write_b128 v164, v[68:71] offset:512
    ds_write_b128 v164, v[72:75] offset:544
    ds_write_b128 v164, v[76:79] offset:576
    ds_write_b128 v164, v[80:83] offset:608
    s_waitcnt lgkmcnt(0)
    s_barrier
K2_FINAL:
    v_add_u32 v126, 71680, v125
    ds_read_b128 v[136:139], v125 offset:0
    ds_read_b128 v[140:143], v125 offset:16
    ds_read_b128 v[144:147], v125 offset:35840
    ds_read_b128 v[148:151], v125 offset:35856
    ds_read_b128 v[152:155], v126 offset:0
    ds_read_b128 v[156:159], v126 offset:16
    ds_read_b128 v[160:163], v126 offset:35840
    ds_read_b128 v[164:167], v126 offset:35856
    s_waitcnt vmcnt(0) lgkmcnt(0)
    v_add_f32 v136, v136, v144
    v_add_f32 v152, v152, v160
    v_add_f32 v137, v137, v145
    v_add_f32 v153, v153, v161
    v_add_f32 v138, v138, v146
    v_add_f32 v154, v154, v162
    v_add_f32 v139, v139, v147
    v_add_f32 v155, v155, v163
    v_add_f32 v136, v136, v152
    v_add_f32 v137, v137, v153
    v_add_f32 v138, v138, v154
    v_add_f32 v139, v139, v155
    v_add_f32 v140, v140, v148
    v_add_f32 v156, v156, v164
    v_add_f32 v141, v141, v149
    v_add_f32 v157, v157, v165
    v_add_f32 v142, v142, v150
    v_add_f32 v158, v158, v166
    v_add_f32 v143, v143, v151
    v_add_f32 v159, v159, v167
    v_add_f32 v140, v140, v156
    v_add_f32 v141, v141, v157
    v_add_f32 v142, v142, v158
    v_add_f32 v143, v143, v159
    v_lshlrev_b32 v127, 16, v128
    v_add_f32 v136, v136, v127
    v_and_b32 v127, 0xffff0000, v128
    v_add_f32 v137, v137, v127
    v_lshlrev_b32 v127, 16, v129
    v_add_f32 v138, v138, v127
    v_and_b32 v127, 0xffff0000, v129
    v_add_f32 v139, v139, v127
    v_lshlrev_b32 v127, 16, v130
    v_add_f32 v140, v140, v127
    v_and_b32 v127, 0xffff0000, v130
    v_add_f32 v141, v141, v127
    v_lshlrev_b32 v127, 16, v131
    v_add_f32 v142, v142, v127
    v_and_b32 v127, 0xffff0000, v131
    v_add_f32 v143, v143, v127
    v_lshlrev_b32 v127, 16, v132
    v_add_f32 v136, v136, v127
    v_and_b32 v127, 0xffff0000, v132
    v_add_f32 v137, v137, v127
    v_lshlrev_b32 v127, 16, v133
    v_add_f32 v138, v138, v127
    v_and_b32 v127, 0xffff0000, v133
    v_add_f32 v139, v139, v127
    v_lshlrev_b32 v127, 16, v134
    v_add_f32 v140, v140, v127
    v_and_b32 v127, 0xffff0000, v134
    v_add_f32 v141, v141, v127
    v_lshlrev_b32 v127, 16, v135
    v_add_f32 v142, v142, v127
    v_and_b32 v127, 0xffff0000, v135
    v_add_f32 v143, v143, v127
    v_cvt_pk_bf16_f32 v144, v136, v137
    v_cvt_pk_bf16_f32 v145, v138, v139
    v_cvt_pk_bf16_f32 v146, v140, v141
    v_cvt_pk_bf16_f32 v147, v142, v143
    buffer_store_dwordx4 v[144:147], v124, s[20:23], 0 offen sc0 sc1
K2_DONE:
    s_endpgm
K2_END:
    s_endpgm
CODE_END:
    s_endpgm
.section .rodata,"a"
.p2align 6
.amdhsa_kernel k1_kernel
  .amdhsa_next_free_vgpr 168
  .amdhsa_next_free_sgpr 102
  .amdhsa_accum_offset 168
  .amdhsa_group_segment_fixed_size 0
  .amdhsa_kernarg_size 104
  .amdhsa_user_sgpr_count 2
  .amdhsa_user_sgpr_kernarg_segment_ptr 1
  .amdhsa_system_sgpr_workgroup_id_x 1
  .amdhsa_float_denorm_mode_32 3
.end_amdhsa_kernel
.p2align 6
.amdhsa_kernel k2_kernel
  .amdhsa_next_free_vgpr 168
  .amdhsa_next_free_sgpr 96
  .amdhsa_accum_offset 168
  .amdhsa_group_segment_fixed_size 0
  .amdhsa_kernarg_size 104
  .amdhsa_user_sgpr_count 2
  .amdhsa_user_sgpr_kernarg_segment_ptr 1
  .amdhsa_system_sgpr_workgroup_id_x 1
  .amdhsa_float_denorm_mode_32 3
.end_amdhsa_kernel
```
